```python
import torch

def _softmax(x, axis=-1):
    return torch.softmax(x, dim=axis)

def _gelu(x):
    return torch.nn.functional.gelu(x, approximate='tanh')

def _silu(x):
    return torch.nn.functional.silu(x)

def _sigmoid(x):
    return torch.sigmoid(x)

def _layernorm(x, axis=-1, eps=1e-05):
    m = x.mean(dim=axis, keepdim=True)
    v = x.var(dim=axis, keepdim=True, unbiased=False)
    return (x - m) / torch.sqrt(v + eps)

def _scatter_add(tgt, idx, src, axis=0):
    return tgt.clone().index_add_(axis, idx, src)

def _segment_sum(src, seg, n):
    out = torch.zeros((n,) + src.shape[1:], dtype=src.dtype)
    return out.index_add_(0, seg, src)

def _pad(x, pw):
    flat = tuple((v for pair in reversed(pw) for v in pair))
    return torch.nn.functional.pad(x, flat)
kernel_name = 'standalone__autoregressive_conv_wavenet__speech'

def setup_inputs():

    _w = lambda a: (lambda t: t.to(torch.bfloat16) if t.is_floating_point() else t)(torch.as_tensor(a))
    B, T, D, K = (2, 4000, 144, 31)
    return {'x': _w((lambda *s: torch.randn(*s, dtype=torch.bfloat16) * 0.1)(B, T, D)), 'w': _w((lambda *s: torch.randn(*s, dtype=torch.bfloat16) * 0.1)(K, D, 2 * D)), 'w_o': _w((lambda *s: torch.randn(*s, dtype=torch.bfloat16) * 0.05)(D, D))}

def reference(x, w, w_o):
    B, T, D = x.shape
    K = w.shape[0]
    dil = 2
    pad = (K - 1) * dil
    xp = _pad(x, ((0, 0), (pad, 0), (0, 0)))
    h = torch.einsum('btc,cd->btd', xp[:, pad:pad + T, :], w[0])
    for i in range(1, K):
        off = pad - i * dil
        h = h + torch.einsum('btc,cd->btd', xp[:, off:off + T, :], w[i])
    f = h[..., :D].clone()
    g = h[..., D:].clone()
    z = torch.tanh(f) * _sigmoid(g)
    return z @ w_o
```

```asm
; @launch grid=(252,1,1) block=(512,1,1) lds=163840
.amdgcn_target "amdgcn-amd-amdhsa--gfx950"
.text
.globl standalone__autoregressive_conv_wavenet__speech_kernel
.p2align 8
.type standalone__autoregressive_conv_wavenet__speech_kernel,@function
standalone__autoregressive_conv_wavenet__speech_kernel:
    s_cmp_ge_u32 s2, 252
    s_cbranch_scc1 L_end
    s_load_dwordx4 s[4:7], s[0:1], 0
    s_load_dwordx4 s[8:11], s[0:1], 16
    s_load_dwordx4 s[12:15], s[0:1], 32
    s_getpc_b64 s[40:41]
L_pc:
    s_lshr_b32 s48, s2, 3
    s_mul_i32 s48, s48, 6
    v_add_u32 v1, s48, v0
    v_lshlrev_b32 v1, 7, v1
    v_min_u32 v1, L_code_end-L_pc-4, v1
    s_mov_b64 exec, 0x3f
    global_load_dword v254, v1, s[40:41]
    s_mov_b64 exec, -1
    v_lshrrev_b32 v1, 6, v0
    v_and_b32 v0, 63, v0
    v_readfirstlane_b32 s47, v1
    s_and_b32 s48, s2, 7
    s_lshr_b32 s49, s2, 3
    s_and_b32 s50, s48, 3
    s_lshr_b32 s48, s48, 2
    s_lshl_b32 s48, s48, 5
    s_add_u32 s48, s48, s49
    s_mul_i32 s42, s48, 9363
    s_lshr_b32 s42, s42, 16
    s_mul_i32 s49, s42, 7
    s_sub_u32 s51, s48, s49
    s_mul_i32 s43, s50, 7
    s_add_u32 s43, s43, s51
    s_lshr_b32 s45, s50, 1
    s_and_b32 s50, s50, 1
    s_mul_i32 s50, s50, 7
    s_add_u32 s44, s50, s51
    s_mul_i32 s52, s43, 7282
    s_lshr_b32 s52, s52, 16
    s_mul_i32 s49, s52, 9
    s_sub_u32 s82, s43, s49
    s_mov_b32 s46, 0
    s_cmp_eq_u32 s82, 0
    s_cselect_b32 s55, 2, 3
    s_mul_i32 s53, s52, s55
    s_sub_u32 s54, 8, s53
    s_min_u32 s54, s54, s55
    v_lshrrev_b32 v3, 2, v0
    v_mul_u32_u24 v3, 576, v3
    v_lshrrev_b32 v4, 5, v0
    v_lshlrev_b32 v4, 1, v4
    v_xor_b32 v4, v4, v0
    v_and_b32 v4, 3, v4
    v_lshlrev_b32 v4, 4, v4
    s_lshl_b32 s48, s42, 6
    v_add3_u32 v3, v3, v4, s48
    v_lshrrev_b32 v12, 2, v0
    v_and_b32 v12, 4, v12
    v_xor_b32 v12, v12, v0
    v_lshlrev_b32 v12, 4, v12
    s_waitcnt lgkmcnt(0)
    s_mul_i32 s48, s45, 1152000
    s_add_u32 s4, s4, s48
    s_addc_u32 s5, s5, 0
    s_mov_b32 s16, s4
    s_and_b32 s17, s5, 0xffff
    s_mov_b32 s18, 1152000
    s_mov_b32 s19, 0x20000
    s_mov_b32 s20, s6
    s_and_b32 s21, s7, 0xffff
    s_mov_b32 s22, 2571264
    s_mov_b32 s23, 0x20000
    s_mov_b32 s84, s12
    s_and_b32 s85, s13, 0xffff
    s_mov_b32 s86, 256
    s_mov_b32 s87, 0x20000
    s_cmp_ge_u32 s2, 8
    s_cbranch_scc1 L_nononce
    s_cmp_lg_u32 s47, 7
    s_cbranch_scc1 L_nononce
    s_memrealtime s[56:57]
    s_waitcnt lgkmcnt(0)
    s_or_b32 s56, s56, 1
    v_mov_b32 v4, s56
    v_mov_b32 v5, 0
    v_mov_b32 v6, 0
    s_mov_b64 exec, 1
    buffer_atomic_cmpswap v[4:5], v6, s[84:87], 0 offen
    s_mov_b64 exec, -1
L_nononce:
    s_mul_i32 s49, s44, 82944
    s_sub_i32 s49, s49, 18432
    s_cmp_ge_u32 s47, 4
    s_cbranch_scc1 L_hfirst
    s_mov_b32 s59, s47
    s_mul_i32 s60, s42, 11
    s_add_u32 s50, s60, s59
L_xl1:
    s_cmp_ge_u32 s50, 99
    s_cselect_b32 s51, 99, 0
    s_sub_u32 s50, s50, s51
    s_lshl_b32 s51, s50, 10
    s_mov_b32 m0, s51
    s_add_i32 s51, s51, s49
    s_cmp_lt_i32 s51, 0
    s_cselect_b32 s58, 0x7fff0000, 0
    v_or_b32 v11, s58, v12
    s_max_i32 s51, s51, 0
    s_add_u32 s50, s50, 4
    s_add_u32 s59, s59, 4
    buffer_load_dwordx4 v11, s[16:19], s51 offen lds
    s_cmp_lt_u32 s59, 99
    s_cbranch_scc1 L_xl1
    s_branch L_xdone
L_hfirst:
    s_sub_u32 s61, s47, 4
    s_add_u32 s56, s53, s61
    s_lshl_b32 s56, s56, 1
    s_mul_i32 s57, s56, 165888
    s_mul_i32 s58, s82, 9216
    s_add_u32 s57, s57, s58
    s_sub_u32 s58, s57, 82944
    s_cmp_eq_u32 s56, 0
    s_cselect_b32 s58, 0, s58
    s_cselect_b32 s59, 0x7fff0000, 0
    s_cmp_ge_u32 s61, s54
    s_cselect_b32 s60, 0x7fff0000, 0
    s_or_b32 s59, s59, s60
    v_or_b32 v24, s59, v3
    v_or_b32 v25, s60, v3
    s_cmp_eq_u32 s61, 3
    s_cbranch_scc1 L_h3first
    buffer_load_dwordx4 v[176:179], v25, s[20:23], s57 offen
    buffer_load_dwordx4 v[180:183], v24, s[20:23], s58 offen
    s_add_u32 s58, s57, 82944
    buffer_load_dwordx4 v[184:187], v25, s[20:23], s58 offen
    s_add_u32 s58, s57, 165888
    buffer_load_dwordx4 v[188:191], v25, s[20:23], s58 offen
    s_add_u32 s58, s57, 248832
    buffer_load_dwordx4 v[192:195], v25, s[20:23], s58 offen
    s_branch L_xdone
L_h3first:
L_xdone:
    s_mov_b32 s36, s8
    s_and_b32 s37, s9, 0xffff
    s_mov_b32 s38, 41472
    s_mov_b32 s39, 0x20000
    s_mov_b32 s24, s14
    s_and_b32 s25, s15, 0xffff
    s_mov_b32 s26, 2654208
    s_mov_b32 s27, 0x20000
    s_add_u32 s48, s14, 4194304
    s_addc_u32 s49, s15, 0
    s_mov_b32 s28, s48
    s_and_b32 s29, s49, 0xffff
    s_mov_b32 s30, 4644864
    s_mov_b32 s31, 0x20000
    s_cmp_ge_u32 s47, 4
    s_cbranch_scc1 L_helper
    v_mov_b32 v14, v3
    v_add_u32 v17, 164864, v3
    v_add_u32 v18, 329728, v3
    v_add_u32 v19, 494592, v3
    s_mul_i32 s48, s47, 663552
    s_lshl_b32 s49, s47, 12
    s_add_u32 m0, s49, 101376
    s_nop 0
    buffer_load_dwordx4 v3, s[20:23], s48 offen lds
    buffer_load_dwordx4 v17, s[20:23], s48 offen offset:1024 lds
    buffer_load_dwordx4 v18, s[20:23], s48 offen offset:2048 lds
    buffer_load_dwordx4 v19, s[20:23], s48 offen offset:3072 lds
    s_setprio 1
    s_lshr_b32 s68, s47, 1
    s_and_b32 s69, s47, 1
    v_bfe_u32 v10, v0, 1, 2
    v_bfe_u32 v11, v0, 3, 1
    v_mul_u32_u24 v11, 36, v11
    v_add_u32 v10, v10, v11
    v_lshrrev_b32 v11, 5, v0
    v_sub_u32 v10, v10, v11
    s_lshl_b32 s70, s68, 1
    s_sub_u32 s70, 4, s70
    v_add_u32 v10, s70, v10
    v_and_b32 v11, 1, v0
    v_bfe_u32 v12, v0, 4, 1
    v_lshlrev_b32 v12, 4, v12
    v_lshl_add_u32 v15, v10, 2, v11
    v_mul_u32_u24 v8, 288, v15
    v_add_u32 v8, v8, v12
    v_lshl_add_u32 v15, v10, 1, v11
    v_bfe_u32 v10, v15, 2, 1
    v_lshlrev_b32 v10, 4, v10
    v_xor_b32 v10, v10, v12
    v_lshl_add_u32 v2, v15, 5, v10
    v_add_u32 v2, 150528, v2
    v_add_u32 v3, 5632, v2
    v_lshrrev_b32 v9, 5, v0
    v_lshlrev_b32 v9, 10, v9
    v_bfe_u32 v10, v0, 4, 1
    v_mul_u32_u24 v10, 544, v10
    v_add_u32 v9, v9, v10
    v_bfe_u32 v10, v0, 2, 2
    v_lshlrev_b32 v10, 6, v10
    v_add_u32 v9, v9, v10
    v_and_b32 v10, 3, v0
    v_lshlrev_b32 v10, 3, v10
    v_add_u32 v9, v9, v10
    s_lshl_b32 s70, s69, 5
    v_xor_b32 v9, s70, v9
    s_lshl_b32 s70, s68, 11
    s_add_u32 s70, s70, 101376
    v_add_u32 v9, s70, v9
    s_mul_i32 s70, s42, 147456
    s_lshl_b32 s71, s68, 13
    s_add_u32 s70, s70, s71
    s_lshl_b32 s71, s69, 10
    s_add_u32 s70, s70, s71
    v_lshlrev_b32 v5, 4, v0
    v_add_u32 v5, s70, v5
    s_mov_b32 s73, s68
    s_mul_i32 s48, s47, 5120
    s_add_u32 s48, s48, 138240
    v_lshlrev_b32 v10, 4, v0
    v_add_u32 v200, s48, v10
    s_xor_b32 s49, s47, 2
    s_mul_i32 s48, s49, 5120
    s_add_u32 s48, s48, 138240
    v_add_u32 v201, s48, v10
    s_lshl_b32 s48, s47, 2
    s_add_u32 s48, s48, 142352
    v_mov_b32 v206, s48
    s_lshl_b32 s48, s49, 2
    s_add_u32 s48, s48, 142352
    v_mov_b32 v207, s48
    s_lshl_b32 s48, s42, 1
    s_add_u32 s48, s48, s69
    s_cmp_lt_u32 s48, 9
    s_mov_b32 s84, 0xbfb8aa3b
    s_cselect_b32 s84, 0xc038aa3b, s84
    s_cselect_b32 s86, 2.0, 1.0
    s_cselect_b32 s49, -1.0, 0
    v_mov_b32 v204, s49
    s_mov_b32 s85, s84
    s_mov_b32 s87, s86
    s_mov_b32 s88, 1.0
    s_mov_b32 s89, 1.0
    v_mov_b32 v205, v204
    s_mul_i32 s49, s43, 165888
    s_lshl_b32 s48, s48, 9
    s_add_u32 s48, s48, s49
    s_add_u32 s48, s48, 9216
    s_mul_i32 s49, s68, 18432
    s_add_u32 s48, s48, s49
    v_lshlrev_b32 v202, 3, v0
    v_add_u32 v202, s48, v202
    v_mov_b32 v16, 0
    v_mov_b32 v17, 0
    v_mov_b32 v18, 0
    v_mov_b32 v19, 0
    v_mov_b32 v20, 0
    v_mov_b32 v21, 0
    v_mov_b32 v22, 0
    v_mov_b32 v23, 0
    v_mov_b32 v24, 0
    v_mov_b32 v25, 0
    v_mov_b32 v26, 0
    v_mov_b32 v27, 0
    v_mov_b32 v28, 0
    v_mov_b32 v29, 0
    v_mov_b32 v30, 0
    v_mov_b32 v31, 0
    v_mov_b32 v32, 0
    v_mov_b32 v33, 0
    v_mov_b32 v34, 0
    v_mov_b32 v35, 0
    v_mov_b32 v36, 0
    v_mov_b32 v37, 0
    v_mov_b32 v38, 0
    v_mov_b32 v39, 0
    v_mov_b32 v40, 0
    v_mov_b32 v41, 0
    v_mov_b32 v42, 0
    v_mov_b32 v43, 0
    v_mov_b32 v44, 0
    v_mov_b32 v45, 0
    v_mov_b32 v46, 0
    v_mov_b32 v47, 0
    v_mov_b32 v48, 0
    v_mov_b32 v49, 0
    v_mov_b32 v50, 0
    v_mov_b32 v51, 0
    v_mov_b32 v52, 0
    v_mov_b32 v53, 0
    v_mov_b32 v54, 0
    v_mov_b32 v55, 0
    v_mov_b32 v56, 0
    v_mov_b32 v57, 0
    v_mov_b32 v58, 0
    v_mov_b32 v59, 0
    v_mov_b32 v60, 0
    v_mov_b32 v61, 0
    v_mov_b32 v62, 0
    v_mov_b32 v63, 0
    v_mov_b32 v64, 0
    v_mov_b32 v65, 0
    v_mov_b32 v66, 0
    v_mov_b32 v67, 0
    v_mov_b32 v68, 0
    v_mov_b32 v69, 0
    v_mov_b32 v70, 0
    v_mov_b32 v71, 0
    v_mov_b32 v72, 0
    v_mov_b32 v73, 0
    v_mov_b32 v74, 0
    v_mov_b32 v75, 0
    v_mov_b32 v76, 0
    v_mov_b32 v77, 0
    v_mov_b32 v78, 0
    v_mov_b32 v79, 0
    v_mov_b32 v80, 0
    v_mov_b32 v81, 0
    v_mov_b32 v82, 0
    v_mov_b32 v83, 0
    v_mov_b32 v84, 0
    v_mov_b32 v85, 0
    v_mov_b32 v86, 0
    v_mov_b32 v87, 0
    s_mov_b32 s61, 0
    s_mov_b32 s63, 0
    v_mov_b32 v4, v9
    s_waitcnt vmcnt(4)
    s_barrier
    v_add_u32 v124, 164864, v14
    v_add_u32 v125, 329728, v14
    v_add_u32 v126, 494592, v14
    s_mul_i32 s48, s47, 663552
    s_add_u32 s48, s48, 9216
    s_lshl_b32 s49, s47, 12
    s_add_u32 m0, s49, 117760
    s_nop 0
    buffer_load_dwordx4 v14, s[20:23], s48 offen lds
    buffer_load_dwordx4 v124, s[20:23], s48 offen offset:1024 lds
    buffer_load_dwordx4 v125, s[20:23], s48 offen offset:2048 lds
    buffer_load_dwordx4 v126, s[20:23], s48 offen offset:3072 lds
    s_add_u32 s48, s48, 9216
    s_add_u32 m0, s49, 134144
    s_nop 0
    buffer_load_dwordx4 v14, s[20:23], s48 offen lds
    buffer_load_dwordx4 v124, s[20:23], s48 offen offset:1024 lds
    buffer_load_dwordx4 v125, s[20:23], s48 offen offset:2048 lds
    buffer_load_dwordx4 v126, s[20:23], s48 offen offset:3072 lds
    s_waitcnt vmcnt(8)
    s_barrier
    ds_read_b128 v[88:91], v2 offset:0
    ds_read_b128 v[92:95], v2 offset:256
    ds_read_b128 v[96:99], v2 offset:512
    ds_read_b128 v[100:103], v2 offset:768
    ds_read_b64_tr_b16 v[196:197], v4 offset:12288
    ds_read_b64_tr_b16 v[198:199], v4 offset:12544
    ds_read_b128 v[104:107], v2 offset:1024
    ds_read_b64_tr_b16 v[192:193], v4 offset:8192
    ds_read_b64_tr_b16 v[194:195], v4 offset:8448
    ds_read_b64_tr_b16 v[188:189], v4 offset:4096
    ds_read_b128 v[108:111], v2 offset:1280
    ds_read_b64_tr_b16 v[190:191], v4 offset:4352
    ds_read_b64_tr_b16 v[184:185], v4 offset:0
    ds_read_b64_tr_b16 v[186:187], v4 offset:256
    ds_read_b128 v[112:115], v2 offset:1536
    ds_read_b128 v[116:119], v2 offset:1792
    ds_read_b128 v[120:123], v2 offset:2048
    ds_read_b128 v[124:127], v2 offset:2304
    ds_read_b128 v[128:131], v2 offset:2560
    ds_read_b128 v[132:135], v2 offset:2816
L_A:
    s_waitcnt lgkmcnt(8)
    v_mfma_f32_16x16x32_bf16 v[16:19], v[196:199], v[88:91], v[16:19]
    s_add_u32 s61, s61, 16384
    s_cmp_eq_u32 s61, 49152
    v_mfma_f32_16x16x32_bf16 v[16:19], v[192:195], v[92:95], v[16:19]
    s_cselect_b32 s61, 0, s61
    v_mfma_f32_16x16x32_bf16 v[20:23], v[196:199], v[92:95], v[20:23]
    v_add_u32 v4, s61, v9
    v_mfma_f32_16x16x32_bf16 v[16:19], v[188:191], v[96:99], v[16:19]
    v_mfma_f32_16x16x32_bf16 v[20:23], v[192:195], v[96:99], v[20:23]
    v_mfma_f32_16x16x32_bf16 v[24:27], v[196:199], v[96:99], v[24:27]
    s_waitcnt lgkmcnt(6)
    v_mfma_f32_16x16x32_bf16 v[16:19], v[184:187], v[100:103], v[16:19]
    s_waitcnt lgkmcnt(0)
    s_waitcnt vmcnt(4)
    s_barrier
    v_mfma_f32_16x16x32_bf16 v[20:23], v[188:191], v[100:103], v[20:23]
    ds_read_b128 v[88:91], v3 offset:0
    v_mfma_f32_16x16x32_bf16 v[24:27], v[192:195], v[100:103], v[24:27]
    ds_read_b128 v[92:95], v3 offset:256
    v_mfma_f32_16x16x32_bf16 v[28:31], v[196:199], v[100:103], v[28:31]
    ds_read_b128 v[96:99], v3 offset:512
    v_mfma_f32_16x16x32_bf16 v[20:23], v[184:187], v[104:107], v[20:23]
    ds_read_b128 v[100:103], v3 offset:768
    v_mfma_f32_16x16x32_bf16 v[24:27], v[188:191], v[104:107], v[24:27]
    ds_read_b64_tr_b16 v[180:181], v4 offset:12288
    v_mfma_f32_16x16x32_bf16 v[28:31], v[192:195], v[104:107], v[28:31]
    ds_read_b64_tr_b16 v[182:183], v4 offset:12544
    v_mfma_f32_16x16x32_bf16 v[32:35], v[196:199], v[104:107], v[32:35]
    ds_read_b128 v[104:107], v3 offset:1024
    v_mfma_f32_16x16x32_bf16 v[24:27], v[184:187], v[108:111], v[24:27]
    ds_read_b64_tr_b16 v[176:177], v4 offset:8192
    v_mfma_f32_16x16x32_bf16 v[28:31], v[188:191], v[108:111], v[28:31]
    ds_read_b64_tr_b16 v[178:179], v4 offset:8448
    v_mfma_f32_16x16x32_bf16 v[32:35], v[192:195], v[108:111], v[32:35]
    ds_read_b64_tr_b16 v[172:173], v4 offset:4096
    v_mfma_f32_16x16x32_bf16 v[36:39], v[196:199], v[108:111], v[36:39]
    ds_read_b128 v[108:111], v3 offset:1280
    v_mfma_f32_16x16x32_bf16 v[28:31], v[184:187], v[112:115], v[28:31]
    ds_read_b64_tr_b16 v[174:175], v4 offset:4352
    v_mfma_f32_16x16x32_bf16 v[32:35], v[188:191], v[112:115], v[32:35]
    ds_read_b64_tr_b16 v[168:169], v4 offset:0
    v_mfma_f32_16x16x32_bf16 v[36:39], v[192:195], v[112:115], v[36:39]
    ds_read_b64_tr_b16 v[170:171], v4 offset:256
    v_mfma_f32_16x16x32_bf16 v[40:43], v[196:199], v[112:115], v[40:43]
    ds_read_b128 v[112:115], v3 offset:1536
    v_mfma_f32_16x16x32_bf16 v[32:35], v[184:187], v[116:119], v[32:35]
    v_mfma_f32_16x16x32_bf16 v[36:39], v[188:191], v[116:119], v[36:39]
    v_mfma_f32_16x16x32_bf16 v[40:43], v[192:195], v[116:119], v[40:43]
    v_mfma_f32_16x16x32_bf16 v[44:47], v[196:199], v[116:119], v[44:47]
    ds_read_b128 v[116:119], v3 offset:1792
    v_mfma_f32_16x16x32_bf16 v[36:39], v[184:187], v[120:123], v[36:39]
    v_mfma_f32_16x16x32_bf16 v[40:43], v[188:191], v[120:123], v[40:43]
    v_mfma_f32_16x16x32_bf16 v[44:47], v[192:195], v[120:123], v[44:47]
    v_mfma_f32_16x16x32_bf16 v[48:51], v[196:199], v[120:123], v[48:51]
    ds_read_b128 v[120:123], v3 offset:2048
    v_mfma_f32_16x16x32_bf16 v[40:43], v[184:187], v[124:127], v[40:43]
    v_mfma_f32_16x16x32_bf16 v[44:47], v[188:191], v[124:127], v[44:47]
    v_mfma_f32_16x16x32_bf16 v[48:51], v[192:195], v[124:127], v[48:51]
    ds_read_b128 v[124:127], v3 offset:2304
    v_mfma_f32_16x16x32_bf16 v[44:47], v[184:187], v[128:131], v[44:47]
    v_mfma_f32_16x16x32_bf16 v[48:51], v[188:191], v[128:131], v[48:51]
    ds_read_b128 v[128:131], v3 offset:2560
    v_mfma_f32_16x16x32_bf16 v[48:51], v[184:187], v[132:135], v[48:51]
    ds_read_b128 v[132:135], v3 offset:2816
    s_waitcnt lgkmcnt(8)
    v_mfma_f32_16x16x32_bf16 v[16:19], v[180:183], v[88:91], v[16:19]
    s_add_u32 s61, s61, 16384
    s_cmp_eq_u32 s61, 49152
    v_mfma_f32_16x16x32_bf16 v[16:19], v[176:179], v[92:95], v[16:19]
    s_cselect_b32 s61, 0, s61
    v_mfma_f32_16x16x32_bf16 v[20:23], v[180:183], v[92:95], v[20:23]
    v_add_u32 v4, s61, v9
    v_mfma_f32_16x16x32_bf16 v[16:19], v[172:175], v[96:99], v[16:19]
    v_mfma_f32_16x16x32_bf16 v[20:23], v[176:179], v[96:99], v[20:23]
    v_mfma_f32_16x16x32_bf16 v[24:27], v[180:183], v[96:99], v[24:27]
    s_waitcnt lgkmcnt(6)
    v_mfma_f32_16x16x32_bf16 v[16:19], v[168:171], v[100:103], v[16:19]
    s_waitcnt lgkmcnt(0)
    s_waitcnt vmcnt(0)
    s_barrier
    v_mfma_f32_16x16x32_bf16 v[20:23], v[172:175], v[100:103], v[20:23]
    ds_read_b128 v[88:91], v2 offset:0
    v_mfma_f32_16x16x32_bf16 v[24:27], v[176:179], v[100:103], v[24:27]
    ds_read_b128 v[92:95], v2 offset:256
    v_mfma_f32_16x16x32_bf16 v[28:31], v[180:183], v[100:103], v[28:31]
    ds_read_b128 v[96:99], v2 offset:512
    v_mfma_f32_16x16x32_bf16 v[20:23], v[168:171], v[104:107], v[20:23]
    ds_read_b128 v[100:103], v2 offset:768
    v_mfma_f32_16x16x32_bf16 v[24:27], v[172:175], v[104:107], v[24:27]
    ds_read_b64_tr_b16 v[196:197], v4 offset:12288
    v_mfma_f32_16x16x32_bf16 v[28:31], v[176:179], v[104:107], v[28:31]
    ds_read_b64_tr_b16 v[198:199], v4 offset:12544
    v_mfma_f32_16x16x32_bf16 v[32:35], v[180:183], v[104:107], v[32:35]
    ds_read_b128 v[104:107], v2 offset:1024
    v_mfma_f32_16x16x32_bf16 v[24:27], v[168:171], v[108:111], v[24:27]
    ds_read_b64_tr_b16 v[192:193], v4 offset:8192
    v_mfma_f32_16x16x32_bf16 v[28:31], v[172:175], v[108:111], v[28:31]
    ds_read_b64_tr_b16 v[194:195], v4 offset:8448
    v_mfma_f32_16x16x32_bf16 v[32:35], v[176:179], v[108:111], v[32:35]
    ds_read_b64_tr_b16 v[188:189], v4 offset:4096
    v_mfma_f32_16x16x32_bf16 v[36:39], v[180:183], v[108:111], v[36:39]
    ds_read_b128 v[108:111], v2 offset:1280
    v_mfma_f32_16x16x32_bf16 v[28:31], v[168:171], v[112:115], v[28:31]
    ds_read_b64_tr_b16 v[190:191], v4 offset:4352
    v_mfma_f32_16x16x32_bf16 v[32:35], v[172:175], v[112:115], v[32:35]
    ds_read_b64_tr_b16 v[184:185], v4 offset:0
    v_mfma_f32_16x16x32_bf16 v[36:39], v[176:179], v[112:115], v[36:39]
    ds_read_b64_tr_b16 v[186:187], v4 offset:256
    v_mfma_f32_16x16x32_bf16 v[40:43], v[180:183], v[112:115], v[40:43]
    ds_read_b128 v[112:115], v2 offset:1536
    v_mfma_f32_16x16x32_bf16 v[32:35], v[168:171], v[116:119], v[32:35]
    v_mfma_f32_16x16x32_bf16 v[36:39], v[172:175], v[116:119], v[36:39]
    v_mfma_f32_16x16x32_bf16 v[40:43], v[176:179], v[116:119], v[40:43]
    v_mfma_f32_16x16x32_bf16 v[44:47], v[180:183], v[116:119], v[44:47]
    ds_read_b128 v[116:119], v2 offset:1792
    v_mfma_f32_16x16x32_bf16 v[36:39], v[168:171], v[120:123], v[36:39]
    v_mfma_f32_16x16x32_bf16 v[40:43], v[172:175], v[120:123], v[40:43]
    v_mfma_f32_16x16x32_bf16 v[44:47], v[176:179], v[120:123], v[44:47]
    v_mfma_f32_16x16x32_bf16 v[48:51], v[180:183], v[120:123], v[48:51]
    ds_read_b128 v[120:123], v2 offset:2048
    v_mfma_f32_16x16x32_bf16 v[40:43], v[168:171], v[124:127], v[40:43]
    v_mfma_f32_16x16x32_bf16 v[44:47], v[172:175], v[124:127], v[44:47]
    v_mfma_f32_16x16x32_bf16 v[48:51], v[176:179], v[124:127], v[48:51]
    ds_read_b128 v[124:127], v2 offset:2304
    v_mfma_f32_16x16x32_bf16 v[44:47], v[168:171], v[128:131], v[44:47]
    v_mfma_f32_16x16x32_bf16 v[48:51], v[172:175], v[128:131], v[48:51]
    ds_read_b128 v[128:131], v2 offset:2560
    v_mfma_f32_16x16x32_bf16 v[48:51], v[168:171], v[132:135], v[48:51]
    ds_read_b128 v[132:135], v2 offset:2816
    s_add_u32 s63, s63, 1
    s_cmp_lt_u32 s63, 3
    s_cbranch_scc1 L_A
    s_waitcnt lgkmcnt(8)
    v_mfma_f32_16x16x32_bf16 v[16:19], v[196:199], v[88:91], v[16:19]
    s_add_u32 s61, s61, 16384
    s_cmp_eq_u32 s61, 49152
    v_mfma_f32_16x16x32_bf16 v[16:19], v[192:195], v[92:95], v[16:19]
    s_cselect_b32 s61, 0, s61
    v_mfma_f32_16x16x32_bf16 v[20:23], v[196:199], v[92:95], v[20:23]
    v_add_u32 v4, s61, v9
    v_mfma_f32_16x16x32_bf16 v[16:19], v[188:191], v[96:99], v[16:19]
    v_mfma_f32_16x16x32_bf16 v[20:23], v[192:195], v[96:99], v[20:23]
    v_mfma_f32_16x16x32_bf16 v[24:27], v[196:199], v[96:99], v[24:27]
    s_waitcnt lgkmcnt(6)
    v_mfma_f32_16x16x32_bf16 v[16:19], v[184:187], v[100:103], v[16:19]
    s_waitcnt lgkmcnt(0)
    s_barrier
    v_mfma_f32_16x16x32_bf16 v[20:23], v[188:191], v[100:103], v[20:23]
    ds_read_b128 v[88:91], v3 offset:0
    v_mfma_f32_16x16x32_bf16 v[24:27], v[192:195], v[100:103], v[24:27]
    ds_read_b128 v[92:95], v3 offset:256
    v_mfma_f32_16x16x32_bf16 v[28:31], v[196:199], v[100:103], v[28:31]
    ds_read_b128 v[96:99], v3 offset:512
    v_mfma_f32_16x16x32_bf16 v[20:23], v[184:187], v[104:107], v[20:23]
    ds_read_b128 v[100:103], v3 offset:768
    v_mfma_f32_16x16x32_bf16 v[24:27], v[188:191], v[104:107], v[24:27]
    ds_read_b64_tr_b16 v[180:181], v4 offset:12288
    v_mfma_f32_16x16x32_bf16 v[28:31], v[192:195], v[104:107], v[28:31]
    ds_read_b64_tr_b16 v[182:183], v4 offset:12544
    v_mfma_f32_16x16x32_bf16 v[32:35], v[196:199], v[104:107], v[32:35]
    ds_read_b128 v[104:107], v3 offset:1024
    v_mfma_f32_16x16x32_bf16 v[24:27], v[184:187], v[108:111], v[24:27]
    ds_read_b64_tr_b16 v[176:177], v4 offset:8192
    v_mfma_f32_16x16x32_bf16 v[28:31], v[188:191], v[108:111], v[28:31]
    ds_read_b64_tr_b16 v[178:179], v4 offset:8448
    v_mfma_f32_16x16x32_bf16 v[32:35], v[192:195], v[108:111], v[32:35]
    ds_read_b64_tr_b16 v[172:173], v4 offset:4096
    v_mfma_f32_16x16x32_bf16 v[36:39], v[196:199], v[108:111], v[36:39]
    ds_read_b128 v[108:111], v3 offset:1280
    v_mfma_f32_16x16x32_bf16 v[28:31], v[184:187], v[112:115], v[28:31]
    ds_read_b64_tr_b16 v[174:175], v4 offset:4352
    v_mfma_f32_16x16x32_bf16 v[32:35], v[188:191], v[112:115], v[32:35]
    ds_read_b64_tr_b16 v[168:169], v4 offset:0
    v_mfma_f32_16x16x32_bf16 v[36:39], v[192:195], v[112:115], v[36:39]
    ds_read_b64_tr_b16 v[170:171], v4 offset:256
    v_mfma_f32_16x16x32_bf16 v[40:43], v[196:199], v[112:115], v[40:43]
    ds_read_b128 v[112:115], v3 offset:1536
    v_mfma_f32_16x16x32_bf16 v[32:35], v[184:187], v[116:119], v[32:35]
    v_mfma_f32_16x16x32_bf16 v[36:39], v[188:191], v[116:119], v[36:39]
    v_mfma_f32_16x16x32_bf16 v[40:43], v[192:195], v[116:119], v[40:43]
    v_mfma_f32_16x16x32_bf16 v[44:47], v[196:199], v[116:119], v[44:47]
    ds_read_b128 v[116:119], v3 offset:1792
    v_mfma_f32_16x16x32_bf16 v[36:39], v[184:187], v[120:123], v[36:39]
    v_mfma_f32_16x16x32_bf16 v[40:43], v[188:191], v[120:123], v[40:43]
    v_mfma_f32_16x16x32_bf16 v[44:47], v[192:195], v[120:123], v[44:47]
    v_mfma_f32_16x16x32_bf16 v[48:51], v[196:199], v[120:123], v[48:51]
    ds_read_b128 v[120:123], v3 offset:2048
    v_mfma_f32_16x16x32_bf16 v[40:43], v[184:187], v[124:127], v[40:43]
    v_mfma_f32_16x16x32_bf16 v[44:47], v[188:191], v[124:127], v[44:47]
    v_mfma_f32_16x16x32_bf16 v[48:51], v[192:195], v[124:127], v[48:51]
    ds_read_b128 v[124:127], v3 offset:2304
    v_mfma_f32_16x16x32_bf16 v[44:47], v[184:187], v[128:131], v[44:47]
    v_mfma_f32_16x16x32_bf16 v[48:51], v[188:191], v[128:131], v[48:51]
    ds_read_b128 v[128:131], v3 offset:2560
    v_mfma_f32_16x16x32_bf16 v[48:51], v[184:187], v[132:135], v[48:51]
    ds_read_b128 v[132:135], v3 offset:2816
    s_waitcnt lgkmcnt(8)
    v_mfma_f32_16x16x32_bf16 v[16:19], v[180:183], v[88:91], v[16:19]
    s_add_u32 s61, s61, 16384
    s_cmp_eq_u32 s61, 49152
    v_mfma_f32_16x16x32_bf16 v[16:19], v[176:179], v[92:95], v[16:19]
    s_cselect_b32 s61, 0, s61
    v_mfma_f32_16x16x32_bf16 v[20:23], v[180:183], v[92:95], v[20:23]
    v_add_u32 v4, s61, v9
    v_mfma_f32_16x16x32_bf16 v[16:19], v[172:175], v[96:99], v[16:19]
    s_mov_b32 s66, 0
    s_mov_b32 s67, 4096
    v_mfma_f32_16x16x32_bf16 v[20:23], v[176:179], v[96:99], v[20:23]
    v_mfma_f32_16x16x32_bf16 v[24:27], v[180:183], v[96:99], v[24:27]
    s_waitcnt lgkmcnt(6)
    v_mfma_f32_16x16x32_bf16 v[16:19], v[168:171], v[100:103], v[16:19]
    s_waitcnt lgkmcnt(0)
    s_barrier
    v_mfma_f32_16x16x32_bf16 v[20:23], v[172:175], v[100:103], v[20:23]
    ds_read_b128 v[88:91], v2 offset:0
    v_mfma_f32_16x16x32_bf16 v[24:27], v[176:179], v[100:103], v[24:27]
    ds_read_b128 v[92:95], v2 offset:256
    v_mfma_f32_16x16x32_bf16 v[28:31], v[180:183], v[100:103], v[28:31]
    ds_read_b128 v[96:99], v2 offset:512
    v_mfma_f32_16x16x32_bf16 v[20:23], v[168:171], v[104:107], v[20:23]
    ds_read_b128 v[100:103], v2 offset:768
    v_mfma_f32_16x16x32_bf16 v[24:27], v[172:175], v[104:107], v[24:27]
    ds_read_b64_tr_b16 v[196:197], v4 offset:12288
    v_mfma_f32_16x16x32_bf16 v[28:31], v[176:179], v[104:107], v[28:31]
    ds_read_b64_tr_b16 v[198:199], v4 offset:12544
    v_mfma_f32_16x16x32_bf16 v[32:35], v[180:183], v[104:107], v[32:35]
    ds_read_b128 v[104:107], v2 offset:1024
    v_mfma_f32_16x16x32_bf16 v[24:27], v[168:171], v[108:111], v[24:27]
    ds_read_b64_tr_b16 v[192:193], v4 offset:8192
    v_mfma_f32_16x16x32_bf16 v[28:31], v[172:175], v[108:111], v[28:31]
    ds_read_b64_tr_b16 v[194:195], v4 offset:8448
    v_mfma_f32_16x16x32_bf16 v[32:35], v[176:179], v[108:111], v[32:35]
    ds_read_b64_tr_b16 v[188:189], v4 offset:4096
    v_mfma_f32_16x16x32_bf16 v[36:39], v[180:183], v[108:111], v[36:39]
    ds_read_b128 v[108:111], v2 offset:1280
    v_mfma_f32_16x16x32_bf16 v[28:31], v[168:171], v[112:115], v[28:31]
    ds_read_b64_tr_b16 v[190:191], v4 offset:4352
    v_mfma_f32_16x16x32_bf16 v[32:35], v[172:175], v[112:115], v[32:35]
    ds_read_b64_tr_b16 v[184:185], v4 offset:0
    v_mfma_f32_16x16x32_bf16 v[36:39], v[176:179], v[112:115], v[36:39]
    ds_read_b64_tr_b16 v[186:187], v4 offset:256
    v_mfma_f32_16x16x32_bf16 v[40:43], v[180:183], v[112:115], v[40:43]
    ds_read_b128 v[112:115], v2 offset:1536
    v_mfma_f32_16x16x32_bf16 v[32:35], v[168:171], v[116:119], v[32:35]
    buffer_load_dwordx4 v[136:139], v5, s[24:27], s66 offen offset:0 sc1
    v_mfma_f32_16x16x32_bf16 v[36:39], v[172:175], v[116:119], v[36:39]
    buffer_load_dwordx4 v[140:143], v5, s[24:27], s66 offen offset:2048 sc1
    v_mfma_f32_16x16x32_bf16 v[40:43], v[176:179], v[116:119], v[40:43]
    buffer_load_dwordx4 v[144:147], v5, s[24:27], s67 offen offset:0 sc1
    v_mfma_f32_16x16x32_bf16 v[44:47], v[180:183], v[116:119], v[44:47]
    ds_read_b128 v[116:119], v2 offset:1792
    v_mfma_f32_16x16x32_bf16 v[36:39], v[168:171], v[120:123], v[36:39]
    buffer_load_dwordx4 v[148:151], v5, s[24:27], s67 offen offset:2048 sc1
    v_mfma_f32_16x16x32_bf16 v[40:43], v[172:175], v[120:123], v[40:43]
    v_mfma_f32_16x16x32_bf16 v[44:47], v[176:179], v[120:123], v[44:47]
    v_mfma_f32_16x16x32_bf16 v[48:51], v[180:183], v[120:123], v[48:51]
    ds_read_b128 v[120:123], v2 offset:2048
    v_mfma_f32_16x16x32_bf16 v[40:43], v[168:171], v[124:127], v[40:43]
    v_mfma_f32_16x16x32_bf16 v[44:47], v[172:175], v[124:127], v[44:47]
    v_mfma_f32_16x16x32_bf16 v[48:51], v[176:179], v[124:127], v[48:51]
    ds_read_b128 v[124:127], v2 offset:2304
    v_mfma_f32_16x16x32_bf16 v[44:47], v[168:171], v[128:131], v[44:47]
    v_mfma_f32_16x16x32_bf16 v[48:51], v[172:175], v[128:131], v[48:51]
    ds_read_b128 v[128:131], v2 offset:2560
    v_mfma_f32_16x16x32_bf16 v[48:51], v[168:171], v[132:135], v[48:51]
    ds_read_b128 v[132:135], v2 offset:2816
    s_waitcnt lgkmcnt(8)
    v_mfma_f32_16x16x32_bf16 v[16:19], v[196:199], v[88:91], v[16:19]
    s_mov_b32 s76, 576
    v_mfma_f32_16x16x32_bf16 v[16:19], v[192:195], v[92:95], v[16:19]
    v_add_u32 v6, s76, v8
    v_mfma_f32_16x16x32_bf16 v[20:23], v[196:199], v[92:95], v[20:23]
    v_lshrrev_b32 v13, 2, v6
    v_mfma_f32_16x16x32_bf16 v[16:19], v[188:191], v[96:99], v[16:19]
    v_and_b32 v13, 64, v13
    s_mov_b32 s66, 16384
    s_mov_b32 s67, 20480
    v_mfma_f32_16x16x32_bf16 v[20:23], v[192:195], v[96:99], v[20:23]
    v_xor_b32 v6, v6, v13
    v_mfma_f32_16x16x32_bf16 v[24:27], v[196:199], v[96:99], v[24:27]
    s_waitcnt lgkmcnt(6)
    v_mfma_f32_16x16x32_bf16 v[16:19], v[184:187], v[100:103], v[16:19]
    s_waitcnt lgkmcnt(0)
    s_barrier
    v_mfma_f32_16x16x32_bf16 v[20:23], v[188:191], v[100:103], v[20:23]
    ds_read_b128 v[88:91], v6 offset:0
    v_mfma_f32_16x16x32_bf16 v[24:27], v[192:195], v[100:103], v[24:27]
    ds_read_b128 v[92:95], v6 offset:4608
    v_mfma_f32_16x16x32_bf16 v[28:31], v[196:199], v[100:103], v[28:31]
    ds_read_b128 v[96:99], v6 offset:9216
    v_mfma_f32_16x16x32_bf16 v[20:23], v[184:187], v[104:107], v[20:23]
    ds_read_b128 v[100:103], v6 offset:13824
    v_mfma_f32_16x16x32_bf16 v[24:27], v[188:191], v[104:107], v[24:27]
    s_mov_b32 s76, 608
    v_mfma_f32_16x16x32_bf16 v[28:31], v[192:195], v[104:107], v[28:31]
    v_add_u32 v7, s76, v8
    v_mfma_f32_16x16x32_bf16 v[32:35], v[196:199], v[104:107], v[32:35]
    ds_read_b128 v[104:107], v6 offset:18432
    v_mfma_f32_16x16x32_bf16 v[24:27], v[184:187], v[108:111], v[24:27]
    v_lshrrev_b32 v13, 2, v7
    v_mfma_f32_16x16x32_bf16 v[28:31], v[188:191], v[108:111], v[28:31]
    v_and_b32 v13, 64, v13
    v_mfma_f32_16x16x32_bf16 v[32:35], v[192:195], v[108:111], v[32:35]
    v_xor_b32 v7, v7, v13
    v_mfma_f32_16x16x32_bf16 v[36:39], v[196:199], v[108:111], v[36:39]
    ds_read_b128 v[108:111], v6 offset:23040
    v_mfma_f32_16x16x32_bf16 v[28:31], v[184:187], v[112:115], v[28:31]
    buffer_load_dwordx4 v[152:155], v5, s[24:27], s66 offen offset:0 sc1
    v_mfma_f32_16x16x32_bf16 v[32:35], v[188:191], v[112:115], v[32:35]
    buffer_load_dwordx4 v[156:159], v5, s[24:27], s66 offen offset:2048 sc1
    v_mfma_f32_16x16x32_bf16 v[36:39], v[192:195], v[112:115], v[36:39]
    buffer_load_dwordx4 v[160:163], v5, s[24:27], s67 offen offset:0 sc1
    v_mfma_f32_16x16x32_bf16 v[40:43], v[196:199], v[112:115], v[40:43]
    ds_read_b128 v[112:115], v6 offset:27648
    v_mfma_f32_16x16x32_bf16 v[32:35], v[184:187], v[116:119], v[32:35]
    buffer_load_dwordx4 v[164:167], v5, s[24:27], s67 offen offset:2048 sc1
    v_mfma_f32_16x16x32_bf16 v[36:39], v[188:191], v[116:119], v[36:39]
    v_mfma_f32_16x16x32_bf16 v[40:43], v[192:195], v[116:119], v[40:43]
    v_mfma_f32_16x16x32_bf16 v[44:47], v[196:199], v[116:119], v[44:47]
    ds_read_b128 v[116:119], v6 offset:32256
    v_mfma_f32_16x16x32_bf16 v[36:39], v[184:187], v[120:123], v[36:39]
    v_mfma_f32_16x16x32_bf16 v[40:43], v[188:191], v[120:123], v[40:43]
    v_mfma_f32_16x16x32_bf16 v[44:47], v[192:195], v[120:123], v[44:47]
    v_mfma_f32_16x16x32_bf16 v[48:51], v[196:199], v[120:123], v[48:51]
    ds_read_b128 v[120:123], v6 offset:36864
    v_mfma_f32_16x16x32_bf16 v[40:43], v[184:187], v[124:127], v[40:43]
    v_mfma_f32_16x16x32_bf16 v[44:47], v[188:191], v[124:127], v[44:47]
    v_mfma_f32_16x16x32_bf16 v[48:51], v[192:195], v[124:127], v[48:51]
    ds_read_b128 v[124:127], v6 offset:41472
    v_mfma_f32_16x16x32_bf16 v[44:47], v[184:187], v[128:131], v[44:47]
    v_mfma_f32_16x16x32_bf16 v[48:51], v[188:191], v[128:131], v[48:51]
    ds_read_b128 v[128:131], v6 offset:46080
    v_mfma_f32_16x16x32_bf16 v[48:51], v[184:187], v[132:135], v[48:51]
    ds_read_b128 v[132:135], v6 offset:50688
    v_mov_b32 v6, v7
    s_mov_b32 s76, 608
    s_mov_b32 s66, 16384
    s_mov_b32 s72, 0
L_B1:
    s_waitcnt lgkmcnt(9) vmcnt(4)
    v_mfma_f32_16x16x32_bf16 v[52:55], v[148:151], v[88:91], v[52:55]
    ds_read_b128 v[88:91], v6 offset:0
    v_mfma_f32_16x16x32_bf16 v[52:55], v[144:147], v[92:95], v[52:55]
    s_add_u32 s76, s76, 32
    s_add_u32 s66, s66, 16384
    v_mfma_f32_16x16x32_bf16 v[56:59], v[148:151], v[92:95], v[56:59]
    ds_read_b128 v[92:95], v6 offset:4608
    v_mfma_f32_16x16x32_bf16 v[52:55], v[140:143], v[96:99], v[52:55]
    v_mfma_f32_16x16x32_bf16 v[56:59], v[144:147], v[96:99], v[56:59]
    s_add_u32 s67, s66, 4096
    v_mfma_f32_16x16x32_bf16 v[60:63], v[148:151], v[96:99], v[60:63]
    ds_read_b128 v[96:99], v6 offset:9216
    s_waitcnt lgkmcnt(10)
    v_mfma_f32_16x16x32_bf16 v[52:55], v[136:139], v[100:103], v[52:55]
    v_add_u32 v7, s76, v8
    v_mfma_f32_16x16x32_bf16 v[56:59], v[140:143], v[100:103], v[56:59]
    v_lshrrev_b32 v13, 2, v7
    v_mfma_f32_16x16x32_bf16 v[60:63], v[144:147], v[100:103], v[60:63]
    v_and_b32 v13, 64, v13
    v_mfma_f32_16x16x32_bf16 v[64:67], v[148:151], v[100:103], v[64:67]
    ds_read_b128 v[100:103], v6 offset:13824
    v_mfma_f32_16x16x32_bf16 v[56:59], v[136:139], v[104:107], v[56:59]
    v_xor_b32 v7, v7, v13
    v_mfma_f32_16x16x32_bf16 v[60:63], v[140:143], v[104:107], v[60:63]
    buffer_load_dwordx4 v[168:171], v5, s[24:27], s66 offen offset:0 sc1
    v_mfma_f32_16x16x32_bf16 v[64:67], v[144:147], v[104:107], v[64:67]
    v_mfma_f32_16x16x32_bf16 v[68:71], v[148:151], v[104:107], v[68:71]
    ds_read_b128 v[104:107], v6 offset:18432
    s_waitcnt lgkmcnt(10)
    v_mfma_f32_16x16x32_bf16 v[60:63], v[136:139], v[108:111], v[60:63]
    v_mfma_f32_16x16x32_bf16 v[64:67], v[140:143], v[108:111], v[64:67]
    buffer_load_dwordx4 v[172:175], v5, s[24:27], s66 offen offset:2048 sc1
    v_mfma_f32_16x16x32_bf16 v[68:71], v[144:147], v[108:111], v[68:71]
    v_mfma_f32_16x16x32_bf16 v[72:75], v[148:151], v[108:111], v[72:75]
    ds_read_b128 v[108:111], v6 offset:23040
    v_mfma_f32_16x16x32_bf16 v[64:67], v[136:139], v[112:115], v[64:67]
    v_mfma_f32_16x16x32_bf16 v[68:71], v[140:143], v[112:115], v[68:71]
    buffer_load_dwordx4 v[176:179], v5, s[24:27], s67 offen offset:0 sc1
    v_mfma_f32_16x16x32_bf16 v[72:75], v[144:147], v[112:115], v[72:75]
    v_mfma_f32_16x16x32_bf16 v[76:79], v[148:151], v[112:115], v[76:79]
    ds_read_b128 v[112:115], v6 offset:27648
    s_waitcnt lgkmcnt(10)
    v_mfma_f32_16x16x32_bf16 v[68:71], v[136:139], v[116:119], v[68:71]
    v_mfma_f32_16x16x32_bf16 v[72:75], v[140:143], v[116:119], v[72:75]
    buffer_load_dwordx4 v[180:183], v5, s[24:27], s67 offen offset:2048 sc1
    v_mfma_f32_16x16x32_bf16 v[76:79], v[144:147], v[116:119], v[76:79]
    v_mfma_f32_16x16x32_bf16 v[80:83], v[148:151], v[116:119], v[80:83]
    ds_read_b128 v[116:119], v6 offset:32256
    v_mfma_f32_16x16x32_bf16 v[72:75], v[136:139], v[120:123], v[72:75]
    v_mfma_f32_16x16x32_bf16 v[76:79], v[140:143], v[120:123], v[76:79]
    v_mfma_f32_16x16x32_bf16 v[80:83], v[144:147], v[120:123], v[80:83]
    v_mfma_f32_16x16x32_bf16 v[84:87], v[148:151], v[120:123], v[84:87]
    ds_read_b128 v[120:123], v6 offset:36864
    s_waitcnt lgkmcnt(10)
    v_mfma_f32_16x16x32_bf16 v[76:79], v[136:139], v[124:127], v[76:79]
    v_mfma_f32_16x16x32_bf16 v[80:83], v[140:143], v[124:127], v[80:83]
    v_mfma_f32_16x16x32_bf16 v[84:87], v[144:147], v[124:127], v[84:87]
    ds_read_b128 v[124:127], v6 offset:41472
    v_mfma_f32_16x16x32_bf16 v[80:83], v[136:139], v[128:131], v[80:83]
    v_mfma_f32_16x16x32_bf16 v[84:87], v[140:143], v[128:131], v[84:87]
    ds_read_b128 v[128:131], v6 offset:46080
    s_waitcnt lgkmcnt(11)
    v_mfma_f32_16x16x32_bf16 v[84:87], v[136:139], v[132:135], v[84:87]
    ds_read_b128 v[132:135], v6 offset:50688
    v_mov_b32 v6, v7
    s_waitcnt lgkmcnt(9) vmcnt(4)
    v_mfma_f32_16x16x32_bf16 v[52:55], v[164:167], v[88:91], v[52:55]
    ds_read_b128 v[88:91], v6 offset:0
    v_mfma_f32_16x16x32_bf16 v[52:55], v[160:163], v[92:95], v[52:55]
    s_add_u32 s76, s76, 32
    s_add_u32 s66, s66, 16384
    s_cmp_eq_u32 s72, 2
    v_mfma_f32_16x16x32_bf16 v[56:59], v[164:167], v[92:95], v[56:59]
    ds_read_b128 v[92:95], v6 offset:4608
    v_mfma_f32_16x16x32_bf16 v[52:55], v[156:159], v[96:99], v[52:55]
    s_cselect_b32 s76, 0, s76
    s_cselect_b32 s66, 1327104, s66
    v_mfma_f32_16x16x32_bf16 v[56:59], v[160:163], v[96:99], v[56:59]
    s_add_u32 s67, s66, 4096
    v_mfma_f32_16x16x32_bf16 v[60:63], v[164:167], v[96:99], v[60:63]
    ds_read_b128 v[96:99], v6 offset:9216
    s_waitcnt lgkmcnt(10)
    v_mfma_f32_16x16x32_bf16 v[52:55], v[152:155], v[100:103], v[52:55]
    v_add_u32 v7, s76, v8
    v_mfma_f32_16x16x32_bf16 v[56:59], v[156:159], v[100:103], v[56:59]
    v_lshrrev_b32 v13, 2, v7
    v_mfma_f32_16x16x32_bf16 v[60:63], v[160:163], v[100:103], v[60:63]
    v_and_b32 v13, 64, v13
    v_mfma_f32_16x16x32_bf16 v[64:67], v[164:167], v[100:103], v[64:67]
    ds_read_b128 v[100:103], v6 offset:13824
    v_mfma_f32_16x16x32_bf16 v[56:59], v[152:155], v[104:107], v[56:59]
    v_xor_b32 v7, v7, v13
    v_mfma_f32_16x16x32_bf16 v[60:63], v[156:159], v[104:107], v[60:63]
    buffer_load_dwordx4 v[136:139], v5, s[24:27], s66 offen offset:0 sc1
    v_mfma_f32_16x16x32_bf16 v[64:67], v[160:163], v[104:107], v[64:67]
    v_mfma_f32_16x16x32_bf16 v[68:71], v[164:167], v[104:107], v[68:71]
    ds_read_b128 v[104:107], v6 offset:18432
    s_waitcnt lgkmcnt(10)
    v_mfma_f32_16x16x32_bf16 v[60:63], v[152:155], v[108:111], v[60:63]
    v_mfma_f32_16x16x32_bf16 v[64:67], v[156:159], v[108:111], v[64:67]
    buffer_load_dwordx4 v[140:143], v5, s[24:27], s66 offen offset:2048 sc1
    v_mfma_f32_16x16x32_bf16 v[68:71], v[160:163], v[108:111], v[68:71]
    v_mfma_f32_16x16x32_bf16 v[72:75], v[164:167], v[108:111], v[72:75]
    ds_read_b128 v[108:111], v6 offset:23040
    v_mfma_f32_16x16x32_bf16 v[64:67], v[152:155], v[112:115], v[64:67]
    v_mfma_f32_16x16x32_bf16 v[68:71], v[156:159], v[112:115], v[68:71]
    buffer_load_dwordx4 v[144:147], v5, s[24:27], s67 offen offset:0 sc1
    v_mfma_f32_16x16x32_bf16 v[72:75], v[160:163], v[112:115], v[72:75]
    v_mfma_f32_16x16x32_bf16 v[76:79], v[164:167], v[112:115], v[76:79]
    ds_read_b128 v[112:115], v6 offset:27648
    s_waitcnt lgkmcnt(10)
    v_mfma_f32_16x16x32_bf16 v[68:71], v[152:155], v[116:119], v[68:71]
    v_mfma_f32_16x16x32_bf16 v[72:75], v[156:159], v[116:119], v[72:75]
    buffer_load_dwordx4 v[148:151], v5, s[24:27], s67 offen offset:2048 sc1
    v_mfma_f32_16x16x32_bf16 v[76:79], v[160:163], v[116:119], v[76:79]
    v_mfma_f32_16x16x32_bf16 v[80:83], v[164:167], v[116:119], v[80:83]
    ds_read_b128 v[116:119], v6 offset:32256
    v_mfma_f32_16x16x32_bf16 v[72:75], v[152:155], v[120:123], v[72:75]
    v_mfma_f32_16x16x32_bf16 v[76:79], v[156:159], v[120:123], v[76:79]
    v_mfma_f32_16x16x32_bf16 v[80:83], v[160:163], v[120:123], v[80:83]
    v_mfma_f32_16x16x32_bf16 v[84:87], v[164:167], v[120:123], v[84:87]
    ds_read_b128 v[120:123], v6 offset:36864
    s_waitcnt lgkmcnt(10)
    v_mfma_f32_16x16x32_bf16 v[76:79], v[152:155], v[124:127], v[76:79]
    v_mfma_f32_16x16x32_bf16 v[80:83], v[156:159], v[124:127], v[80:83]
    v_mfma_f32_16x16x32_bf16 v[84:87], v[160:163], v[124:127], v[84:87]
    ds_read_b128 v[124:127], v6 offset:41472
    v_mfma_f32_16x16x32_bf16 v[80:83], v[152:155], v[128:131], v[80:83]
    v_mfma_f32_16x16x32_bf16 v[84:87], v[156:159], v[128:131], v[84:87]
    ds_read_b128 v[128:131], v6 offset:46080
    s_waitcnt lgkmcnt(11)
    v_mfma_f32_16x16x32_bf16 v[84:87], v[152:155], v[132:135], v[84:87]
    ds_read_b128 v[132:135], v6 offset:50688
    v_mov_b32 v6, v7
    s_waitcnt lgkmcnt(9) vmcnt(4)
    v_mfma_f32_16x16x32_bf16 v[52:55], v[180:183], v[88:91], v[52:55]
    ds_read_b128 v[88:91], v6 offset:0
    v_mfma_f32_16x16x32_bf16 v[52:55], v[176:179], v[92:95], v[52:55]
    s_add_u32 s76, s76, 32
    s_add_u32 s66, s66, 16384
    v_mfma_f32_16x16x32_bf16 v[56:59], v[180:183], v[92:95], v[56:59]
    ds_read_b128 v[92:95], v6 offset:4608
    v_mfma_f32_16x16x32_bf16 v[52:55], v[172:175], v[96:99], v[52:55]
    v_mfma_f32_16x16x32_bf16 v[56:59], v[176:179], v[96:99], v[56:59]
    s_add_u32 s67, s66, 4096
    v_mfma_f32_16x16x32_bf16 v[60:63], v[180:183], v[96:99], v[60:63]
    ds_read_b128 v[96:99], v6 offset:9216
    s_waitcnt lgkmcnt(10)
    v_mfma_f32_16x16x32_bf16 v[52:55], v[168:171], v[100:103], v[52:55]
    v_add_u32 v7, s76, v8
    v_mfma_f32_16x16x32_bf16 v[56:59], v[172:175], v[100:103], v[56:59]
    v_lshrrev_b32 v13, 2, v7
    v_mfma_f32_16x16x32_bf16 v[60:63], v[176:179], v[100:103], v[60:63]
    v_and_b32 v13, 64, v13
    v_mfma_f32_16x16x32_bf16 v[64:67], v[180:183], v[100:103], v[64:67]
    ds_read_b128 v[100:103], v6 offset:13824
    v_mfma_f32_16x16x32_bf16 v[56:59], v[168:171], v[104:107], v[56:59]
    v_xor_b32 v7, v7, v13
    v_mfma_f32_16x16x32_bf16 v[60:63], v[172:175], v[104:107], v[60:63]
    buffer_load_dwordx4 v[152:155], v5, s[24:27], s66 offen offset:0 sc1
    v_mfma_f32_16x16x32_bf16 v[64:67], v[176:179], v[104:107], v[64:67]
    v_mfma_f32_16x16x32_bf16 v[68:71], v[180:183], v[104:107], v[68:71]
    ds_read_b128 v[104:107], v6 offset:18432
    s_waitcnt lgkmcnt(10)
    v_mfma_f32_16x16x32_bf16 v[60:63], v[168:171], v[108:111], v[60:63]
    v_mfma_f32_16x16x32_bf16 v[64:67], v[172:175], v[108:111], v[64:67]
    buffer_load_dwordx4 v[156:159], v5, s[24:27], s66 offen offset:2048 sc1
    v_mfma_f32_16x16x32_bf16 v[68:71], v[176:179], v[108:111], v[68:71]
    v_mfma_f32_16x16x32_bf16 v[72:75], v[180:183], v[108:111], v[72:75]
    ds_read_b128 v[108:111], v6 offset:23040
    v_mfma_f32_16x16x32_bf16 v[64:67], v[168:171], v[112:115], v[64:67]
    v_mfma_f32_16x16x32_bf16 v[68:71], v[172:175], v[112:115], v[68:71]
    buffer_load_dwordx4 v[160:163], v5, s[24:27], s67 offen offset:0 sc1
    v_mfma_f32_16x16x32_bf16 v[72:75], v[176:179], v[112:115], v[72:75]
    v_mfma_f32_16x16x32_bf16 v[76:79], v[180:183], v[112:115], v[76:79]
    ds_read_b128 v[112:115], v6 offset:27648
    s_waitcnt lgkmcnt(10)
    v_mfma_f32_16x16x32_bf16 v[68:71], v[168:171], v[116:119], v[68:71]
    v_mfma_f32_16x16x32_bf16 v[72:75], v[172:175], v[116:119], v[72:75]
    buffer_load_dwordx4 v[164:167], v5, s[24:27], s67 offen offset:2048 sc1
    v_mfma_f32_16x16x32_bf16 v[76:79], v[176:179], v[116:119], v[76:79]
    v_mfma_f32_16x16x32_bf16 v[80:83], v[180:183], v[116:119], v[80:83]
    ds_read_b128 v[116:119], v6 offset:32256
    v_mfma_f32_16x16x32_bf16 v[72:75], v[168:171], v[120:123], v[72:75]
    v_mfma_f32_16x16x32_bf16 v[76:79], v[172:175], v[120:123], v[76:79]
    v_mfma_f32_16x16x32_bf16 v[80:83], v[176:179], v[120:123], v[80:83]
    v_mfma_f32_16x16x32_bf16 v[84:87], v[180:183], v[120:123], v[84:87]
    ds_read_b128 v[120:123], v6 offset:36864
    s_waitcnt lgkmcnt(10)
    v_mfma_f32_16x16x32_bf16 v[76:79], v[168:171], v[124:127], v[76:79]
    v_mfma_f32_16x16x32_bf16 v[80:83], v[172:175], v[124:127], v[80:83]
    v_mfma_f32_16x16x32_bf16 v[84:87], v[176:179], v[124:127], v[84:87]
    ds_read_b128 v[124:127], v6 offset:41472
    v_mfma_f32_16x16x32_bf16 v[80:83], v[168:171], v[128:131], v[80:83]
    v_mfma_f32_16x16x32_bf16 v[84:87], v[172:175], v[128:131], v[84:87]
    ds_read_b128 v[128:131], v6 offset:46080
    s_waitcnt lgkmcnt(11)
    v_mfma_f32_16x16x32_bf16 v[84:87], v[168:171], v[132:135], v[84:87]
    ds_read_b128 v[132:135], v6 offset:50688
    v_mov_b32 v6, v7
    s_barrier
    s_add_u32 s72, s72, 1
    s_cmp_lt_u32 s72, 3
    s_cbranch_scc1 L_B1
    s_mul_i32 s69, s47, 9216
    s_add_u32 s69, s69, 101376
    v_lshlrev_b32 v10, 4, v0
    v_add_u32 v10, s69, v10
    v_add_f32 v52, v16, v52
    v_add_f32 v53, v17, v53
    v_add_f32 v54, v18, v54
    v_add_f32 v55, v19, v55
    s_waitcnt lgkmcnt(9) vmcnt(4)
    v_mfma_f32_16x16x32_bf16 v[16:19], v[148:151], v[88:91], v[16:19]
    ds_read_b128 v[88:91], v6 offset:0
    v_add_f32 v56, v20, v56
    v_add_f32 v57, v21, v57
    v_mfma_f32_16x16x32_bf16 v[16:19], v[144:147], v[92:95], v[16:19]
    s_add_u32 s76, s76, 32
    s_add_u32 s66, s66, 16384
    v_add_f32 v58, v22, v58
    v_add_f32 v59, v23, v59
    v_mfma_f32_16x16x32_bf16 v[20:23], v[148:151], v[92:95], v[20:23]
    ds_read_b128 v[92:95], v6 offset:4608
    v_add_f32 v60, v24, v60
    v_add_f32 v61, v25, v61
    v_mfma_f32_16x16x32_bf16 v[16:19], v[140:143], v[96:99], v[16:19]
    ds_write_b128 v10, v[52:55] offset:0
    v_add_f32 v62, v26, v62
    v_mfma_f32_16x16x32_bf16 v[20:23], v[144:147], v[96:99], v[20:23]
    s_add_u32 s67, s66, 4096
    v_add_f32 v63, v27, v63
    v_mfma_f32_16x16x32_bf16 v[24:27], v[148:151], v[96:99], v[24:27]
    ds_read_b128 v[96:99], v6 offset:9216
    v_add_f32 v64, v28, v64
    s_waitcnt lgkmcnt(11)
    v_mfma_f32_16x16x32_bf16 v[16:19], v[136:139], v[100:103], v[16:19]
    v_add_u32 v7, s76, v8
    v_add_f32 v65, v29, v65
    v_mfma_f32_16x16x32_bf16 v[20:23], v[140:143], v[100:103], v[20:23]
    v_lshrrev_b32 v13, 2, v7
    ds_write_b128 v10, v[56:59] offset:1024
    v_add_f32 v66, v30, v66
    v_mfma_f32_16x16x32_bf16 v[24:27], v[144:147], v[100:103], v[24:27]
    v_and_b32 v13, 64, v13
    v_add_f32 v67, v31, v67
    v_mfma_f32_16x16x32_bf16 v[28:31], v[148:151], v[100:103], v[28:31]
    ds_read_b128 v[100:103], v6 offset:13824
    v_add_f32 v68, v32, v68
    v_mfma_f32_16x16x32_bf16 v[20:23], v[136:139], v[104:107], v[20:23]
    v_xor_b32 v7, v7, v13
    v_add_f32 v69, v33, v69
    v_mfma_f32_16x16x32_bf16 v[24:27], v[140:143], v[104:107], v[24:27]
    buffer_load_dwordx4 v[168:171], v5, s[24:27], s66 offen offset:0 sc1
    ds_write_b128 v10, v[60:63] offset:2048
    v_add_f32 v70, v34, v70
    v_mfma_f32_16x16x32_bf16 v[28:31], v[144:147], v[104:107], v[28:31]
    v_add_f32 v71, v35, v71
    v_mfma_f32_16x16x32_bf16 v[32:35], v[148:151], v[104:107], v[32:35]
    ds_read_b128 v[104:107], v6 offset:18432
    v_add_f32 v72, v36, v72
    s_waitcnt lgkmcnt(13)
    v_mfma_f32_16x16x32_bf16 v[24:27], v[136:139], v[108:111], v[24:27]
    v_add_f32 v73, v37, v73
    v_mfma_f32_16x16x32_bf16 v[28:31], v[140:143], v[108:111], v[28:31]
    buffer_load_dwordx4 v[172:175], v5, s[24:27], s66 offen offset:2048 sc1
    ds_write_b128 v10, v[64:67] offset:3072
    v_add_f32 v74, v38, v74
    v_mfma_f32_16x16x32_bf16 v[32:35], v[144:147], v[108:111], v[32:35]
    v_add_f32 v75, v39, v75
    v_mfma_f32_16x16x32_bf16 v[36:39], v[148:151], v[108:111], v[36:39]
    ds_read_b128 v[108:111], v6 offset:23040
    v_add_f32 v76, v40, v76
    v_mfma_f32_16x16x32_bf16 v[28:31], v[136:139], v[112:115], v[28:31]
    v_add_f32 v77, v41, v77
    v_mfma_f32_16x16x32_bf16 v[32:35], v[140:143], v[112:115], v[32:35]
    buffer_load_dwordx4 v[176:179], v5, s[24:27], s67 offen offset:0 sc1
    ds_write_b128 v10, v[68:71] offset:4096
    v_add_f32 v78, v42, v78
    v_mfma_f32_16x16x32_bf16 v[36:39], v[144:147], v[112:115], v[36:39]
    v_add_f32 v79, v43, v79
    v_mfma_f32_16x16x32_bf16 v[40:43], v[148:151], v[112:115], v[40:43]
    ds_read_b128 v[112:115], v6 offset:27648
    v_add_f32 v80, v44, v80
    s_waitcnt lgkmcnt(15)
    v_mfma_f32_16x16x32_bf16 v[32:35], v[136:139], v[116:119], v[32:35]
    v_add_f32 v81, v45, v81
    v_mfma_f32_16x16x32_bf16 v[36:39], v[140:143], v[116:119], v[36:39]
    buffer_load_dwordx4 v[180:183], v5, s[24:27], s67 offen offset:2048 sc1
    ds_write_b128 v10, v[72:75] offset:5120
    v_add_f32 v82, v46, v82
    v_mfma_f32_16x16x32_bf16 v[40:43], v[144:147], v[116:119], v[40:43]
    v_add_f32 v83, v47, v83
    v_mfma_f32_16x16x32_bf16 v[44:47], v[148:151], v[116:119], v[44:47]
    ds_read_b128 v[116:119], v6 offset:32256
    v_add_f32 v84, v48, v84
    v_mfma_f32_16x16x32_bf16 v[36:39], v[136:139], v[120:123], v[36:39]
    v_add_f32 v85, v49, v85
    v_mfma_f32_16x16x32_bf16 v[40:43], v[140:143], v[120:123], v[40:43]
    ds_write_b128 v10, v[76:79] offset:6144
    v_add_f32 v86, v50, v86
    v_mfma_f32_16x16x32_bf16 v[44:47], v[144:147], v[120:123], v[44:47]
    v_add_f32 v87, v51, v87
    v_mfma_f32_16x16x32_bf16 v[48:51], v[148:151], v[120:123], v[48:51]
    ds_read_b128 v[120:123], v6 offset:36864
    s_waitcnt lgkmcnt(15)
    v_mfma_f32_16x16x32_bf16 v[40:43], v[136:139], v[124:127], v[40:43]
    v_mfma_f32_16x16x32_bf16 v[44:47], v[140:143], v[124:127], v[44:47]
    ds_write_b128 v10, v[80:83] offset:7168
    v_mfma_f32_16x16x32_bf16 v[48:51], v[144:147], v[124:127], v[48:51]
    ds_read_b128 v[124:127], v6 offset:41472
    v_mfma_f32_16x16x32_bf16 v[44:47], v[136:139], v[128:131], v[44:47]
    ds_write_b128 v10, v[84:87] offset:8192
    v_mfma_f32_16x16x32_bf16 v[48:51], v[140:143], v[128:131], v[48:51]
    ds_read_b128 v[128:131], v6 offset:46080
    v_mfma_f32_16x16x32_bf16 v[48:51], v[136:139], v[132:135], v[48:51]
    ds_read_b128 v[132:135], v6 offset:50688
    v_mov_b32 v6, v7
    s_waitcnt vmcnt(4)
    v_mfma_f32_16x16x32_bf16 v[16:19], v[164:167], v[88:91], v[16:19]
    ds_read_b128 v[88:91], v6 offset:0
    s_waitcnt lgkmcnt(15)
    v_mfma_f32_16x16x32_bf16 v[16:19], v[160:163], v[92:95], v[16:19]
    s_add_u32 s76, s76, 32
    s_add_u32 s66, s66, 16384
    v_mfma_f32_16x16x32_bf16 v[20:23], v[164:167], v[92:95], v[20:23]
    ds_read_b128 v[92:95], v6 offset:4608
    v_mfma_f32_16x16x32_bf16 v[16:19], v[156:159], v[96:99], v[16:19]
    v_mfma_f32_16x16x32_bf16 v[20:23], v[160:163], v[96:99], v[20:23]
    s_add_u32 s67, s66, 4096
    v_mfma_f32_16x16x32_bf16 v[24:27], v[164:167], v[96:99], v[24:27]
    ds_read_b128 v[96:99], v6 offset:9216
    v_mfma_f32_16x16x32_bf16 v[16:19], v[152:155], v[100:103], v[16:19]
    v_add_u32 v7, s76, v8
    v_mfma_f32_16x16x32_bf16 v[20:23], v[156:159], v[100:103], v[20:23]
    v_lshrrev_b32 v13, 2, v7
    v_mfma_f32_16x16x32_bf16 v[24:27], v[160:163], v[100:103], v[24:27]
    v_and_b32 v13, 64, v13
    v_mfma_f32_16x16x32_bf16 v[28:31], v[164:167], v[100:103], v[28:31]
    ds_read_b128 v[100:103], v6 offset:13824
    s_waitcnt lgkmcnt(15)
    v_mfma_f32_16x16x32_bf16 v[20:23], v[152:155], v[104:107], v[20:23]
    v_xor_b32 v7, v7, v13
    v_mfma_f32_16x16x32_bf16 v[24:27], v[156:159], v[104:107], v[24:27]
    buffer_load_dwordx4 v[136:139], v5, s[24:27], s66 offen offset:0 sc1
    v_mfma_f32_16x16x32_bf16 v[28:31], v[160:163], v[104:107], v[28:31]
    v_mfma_f32_16x16x32_bf16 v[32:35], v[164:167], v[104:107], v[32:35]
    ds_read_b128 v[104:107], v6 offset:18432
    v_mfma_f32_16x16x32_bf16 v[24:27], v[152:155], v[108:111], v[24:27]
    v_mfma_f32_16x16x32_bf16 v[28:31], v[156:159], v[108:111], v[28:31]
    buffer_load_dwordx4 v[140:143], v5, s[24:27], s66 offen offset:2048 sc1
    v_mfma_f32_16x16x32_bf16 v[32:35], v[160:163], v[108:111], v[32:35]
    s_waitcnt lgkmcnt(7)
    s_barrier
    v_mfma_f32_16x16x32_bf16 v[36:39], v[164:167], v[108:111], v[36:39]
    ds_read_b128 v[108:111], v6 offset:23040
    v_mfma_f32_16x16x32_bf16 v[28:31], v[152:155], v[112:115], v[28:31]
    v_mfma_f32_16x16x32_bf16 v[32:35], v[156:159], v[112:115], v[32:35]
    buffer_load_dwordx4 v[144:147], v5, s[24:27], s67 offen offset:0 sc1
    v_mfma_f32_16x16x32_bf16 v[36:39], v[160:163], v[112:115], v[36:39]
    v_mfma_f32_16x16x32_bf16 v[40:43], v[164:167], v[112:115], v[40:43]
    ds_read_b128 v[112:115], v6 offset:27648
    v_mfma_f32_16x16x32_bf16 v[32:35], v[152:155], v[116:119], v[32:35]
    v_mfma_f32_16x16x32_bf16 v[36:39], v[156:159], v[116:119], v[36:39]
    buffer_load_dwordx4 v[148:151], v5, s[24:27], s67 offen offset:2048 sc1
    v_mfma_f32_16x16x32_bf16 v[40:43], v[160:163], v[116:119], v[40:43]
    v_mfma_f32_16x16x32_bf16 v[44:47], v[164:167], v[116:119], v[44:47]
    ds_read_b128 v[116:119], v6 offset:32256
    v_mfma_f32_16x16x32_bf16 v[36:39], v[152:155], v[120:123], v[36:39]
    v_mfma_f32_16x16x32_bf16 v[40:43], v[156:159], v[120:123], v[40:43]
    v_mfma_f32_16x16x32_bf16 v[44:47], v[160:163], v[120:123], v[44:47]
    v_mfma_f32_16x16x32_bf16 v[48:51], v[164:167], v[120:123], v[48:51]
    ds_read_b128 v[120:123], v6 offset:36864
    v_mfma_f32_16x16x32_bf16 v[40:43], v[152:155], v[124:127], v[40:43]
    v_mfma_f32_16x16x32_bf16 v[44:47], v[156:159], v[124:127], v[44:47]
    v_mfma_f32_16x16x32_bf16 v[48:51], v[160:163], v[124:127], v[48:51]
    ds_read_b128 v[124:127], v6 offset:41472
    s_waitcnt lgkmcnt(10)
    v_mfma_f32_16x16x32_bf16 v[44:47], v[152:155], v[128:131], v[44:47]
    v_mfma_f32_16x16x32_bf16 v[48:51], v[156:159], v[128:131], v[48:51]
    ds_read_b128 v[128:131], v6 offset:46080
    v_mfma_f32_16x16x32_bf16 v[48:51], v[152:155], v[132:135], v[48:51]
    ds_read_b128 v[132:135], v6 offset:50688
    v_mov_b32 v6, v7
    s_waitcnt lgkmcnt(9) vmcnt(4)
    v_mfma_f32_16x16x32_bf16 v[16:19], v[180:183], v[88:91], v[16:19]
    ds_read_b128 v[88:91], v6 offset:0
    v_mfma_f32_16x16x32_bf16 v[16:19], v[176:179], v[92:95], v[16:19]
    s_add_u32 s76, s76, 32
    s_add_u32 s66, s66, 16384
    v_mfma_f32_16x16x32_bf16 v[20:23], v[180:183], v[92:95], v[20:23]
    ds_read_b128 v[92:95], v6 offset:4608
    v_mfma_f32_16x16x32_bf16 v[16:19], v[172:175], v[96:99], v[16:19]
    v_mfma_f32_16x16x32_bf16 v[20:23], v[176:179], v[96:99], v[20:23]
    s_add_u32 s67, s66, 4096
    v_mfma_f32_16x16x32_bf16 v[24:27], v[180:183], v[96:99], v[24:27]
    ds_read_b128 v[96:99], v6 offset:9216
    s_waitcnt lgkmcnt(10)
    v_mfma_f32_16x16x32_bf16 v[16:19], v[168:171], v[100:103], v[16:19]
    v_add_u32 v7, s76, v8
    v_mfma_f32_16x16x32_bf16 v[20:23], v[172:175], v[100:103], v[20:23]
    v_lshrrev_b32 v13, 2, v7
    v_mfma_f32_16x16x32_bf16 v[24:27], v[176:179], v[100:103], v[24:27]
    v_and_b32 v13, 64, v13
    v_mfma_f32_16x16x32_bf16 v[28:31], v[180:183], v[100:103], v[28:31]
    ds_read_b128 v[100:103], v6 offset:13824
    v_mfma_f32_16x16x32_bf16 v[20:23], v[168:171], v[104:107], v[20:23]
    v_xor_b32 v7, v7, v13
    v_mfma_f32_16x16x32_bf16 v[24:27], v[172:175], v[104:107], v[24:27]
    buffer_load_dwordx4 v[152:155], v5, s[24:27], s66 offen offset:0 sc1
    v_mfma_f32_16x16x32_bf16 v[28:31], v[176:179], v[104:107], v[28:31]
    v_mfma_f32_16x16x32_bf16 v[32:35], v[180:183], v[104:107], v[32:35]
    ds_read_b128 v[104:107], v6 offset:18432
    s_waitcnt lgkmcnt(10)
    v_mfma_f32_16x16x32_bf16 v[24:27], v[168:171], v[108:111], v[24:27]
    v_mfma_f32_16x16x32_bf16 v[28:31], v[172:175], v[108:111], v[28:31]
    buffer_load_dwordx4 v[156:159], v5, s[24:27], s66 offen offset:2048 sc1
    v_mfma_f32_16x16x32_bf16 v[32:35], v[176:179], v[108:111], v[32:35]
    v_mfma_f32_16x16x32_bf16 v[36:39], v[180:183], v[108:111], v[36:39]
    ds_read_b128 v[108:111], v6 offset:23040
    v_mfma_f32_16x16x32_bf16 v[28:31], v[168:171], v[112:115], v[28:31]
    v_mfma_f32_16x16x32_bf16 v[32:35], v[172:175], v[112:115], v[32:35]
    buffer_load_dwordx4 v[160:163], v5, s[24:27], s67 offen offset:0 sc1
    v_mfma_f32_16x16x32_bf16 v[36:39], v[176:179], v[112:115], v[36:39]
    v_mfma_f32_16x16x32_bf16 v[40:43], v[180:183], v[112:115], v[40:43]
    ds_read_b128 v[112:115], v6 offset:27648
    s_waitcnt lgkmcnt(10)
    v_mfma_f32_16x16x32_bf16 v[32:35], v[168:171], v[116:119], v[32:35]
    v_mfma_f32_16x16x32_bf16 v[36:39], v[172:175], v[116:119], v[36:39]
    buffer_load_dwordx4 v[164:167], v5, s[24:27], s67 offen offset:2048 sc1
    v_mfma_f32_16x16x32_bf16 v[40:43], v[176:179], v[116:119], v[40:43]
    v_mfma_f32_16x16x32_bf16 v[44:47], v[180:183], v[116:119], v[44:47]
    ds_read_b128 v[116:119], v6 offset:32256
    v_mfma_f32_16x16x32_bf16 v[36:39], v[168:171], v[120:123], v[36:39]
    v_mfma_f32_16x16x32_bf16 v[40:43], v[172:175], v[120:123], v[40:43]
    v_mfma_f32_16x16x32_bf16 v[44:47], v[176:179], v[120:123], v[44:47]
    v_mfma_f32_16x16x32_bf16 v[48:51], v[180:183], v[120:123], v[48:51]
    ds_read_b128 v[120:123], v6 offset:36864
    s_waitcnt lgkmcnt(10)
    v_mfma_f32_16x16x32_bf16 v[40:43], v[168:171], v[124:127], v[40:43]
    v_mfma_f32_16x16x32_bf16 v[44:47], v[172:175], v[124:127], v[44:47]
    v_mfma_f32_16x16x32_bf16 v[48:51], v[176:179], v[124:127], v[48:51]
    ds_read_b128 v[124:127], v6 offset:41472
    v_mfma_f32_16x16x32_bf16 v[44:47], v[168:171], v[128:131], v[44:47]
    v_mfma_f32_16x16x32_bf16 v[48:51], v[172:175], v[128:131], v[48:51]
    ds_read_b128 v[128:131], v6 offset:46080
    s_waitcnt lgkmcnt(11)
    v_mfma_f32_16x16x32_bf16 v[48:51], v[168:171], v[132:135], v[48:51]
    ds_read_b128 v[132:135], v6 offset:50688
    v_mov_b32 v6, v7
    s_mov_b32 s72, 1
L_B2:
    s_waitcnt lgkmcnt(9) vmcnt(4)
    v_mfma_f32_16x16x32_bf16 v[16:19], v[148:151], v[88:91], v[16:19]
    ds_read_b128 v[88:91], v6 offset:0
    v_mfma_f32_16x16x32_bf16 v[16:19], v[144:147], v[92:95], v[16:19]
    s_add_u32 s76, s76, 32
    s_add_u32 s66, s66, 16384
    v_mfma_f32_16x16x32_bf16 v[20:23], v[148:151], v[92:95], v[20:23]
    ds_read_b128 v[92:95], v6 offset:4608
    v_mfma_f32_16x16x32_bf16 v[16:19], v[140:143], v[96:99], v[16:19]
    v_mfma_f32_16x16x32_bf16 v[20:23], v[144:147], v[96:99], v[20:23]
    s_add_u32 s67, s66, 4096
    v_mfma_f32_16x16x32_bf16 v[24:27], v[148:151], v[96:99], v[24:27]
    ds_read_b128 v[96:99], v6 offset:9216
    s_waitcnt lgkmcnt(10)
    v_mfma_f32_16x16x32_bf16 v[16:19], v[136:139], v[100:103], v[16:19]
    v_add_u32 v7, s76, v8
    v_mfma_f32_16x16x32_bf16 v[20:23], v[140:143], v[100:103], v[20:23]
    v_lshrrev_b32 v13, 2, v7
    v_mfma_f32_16x16x32_bf16 v[24:27], v[144:147], v[100:103], v[24:27]
    v_and_b32 v13, 64, v13
    v_mfma_f32_16x16x32_bf16 v[28:31], v[148:151], v[100:103], v[28:31]
    ds_read_b128 v[100:103], v6 offset:13824
    v_mfma_f32_16x16x32_bf16 v[20:23], v[136:139], v[104:107], v[20:23]
    v_xor_b32 v7, v7, v13
    v_mfma_f32_16x16x32_bf16 v[24:27], v[140:143], v[104:107], v[24:27]
    buffer_load_dwordx4 v[168:171], v5, s[24:27], s66 offen offset:0 sc1
    v_mfma_f32_16x16x32_bf16 v[28:31], v[144:147], v[104:107], v[28:31]
    v_mfma_f32_16x16x32_bf16 v[32:35], v[148:151], v[104:107], v[32:35]
    ds_read_b128 v[104:107], v6 offset:18432
    s_waitcnt lgkmcnt(10)
    v_mfma_f32_16x16x32_bf16 v[24:27], v[136:139], v[108:111], v[24:27]
    v_mfma_f32_16x16x32_bf16 v[28:31], v[140:143], v[108:111], v[28:31]
    buffer_load_dwordx4 v[172:175], v5, s[24:27], s66 offen offset:2048 sc1
    v_mfma_f32_16x16x32_bf16 v[32:35], v[144:147], v[108:111], v[32:35]
    v_mfma_f32_16x16x32_bf16 v[36:39], v[148:151], v[108:111], v[36:39]
    ds_read_b128 v[108:111], v6 offset:23040
    v_mfma_f32_16x16x32_bf16 v[28:31], v[136:139], v[112:115], v[28:31]
    v_mfma_f32_16x16x32_bf16 v[32:35], v[140:143], v[112:115], v[32:35]
    buffer_load_dwordx4 v[176:179], v5, s[24:27], s67 offen offset:0 sc1
    v_mfma_f32_16x16x32_bf16 v[36:39], v[144:147], v[112:115], v[36:39]
    v_mfma_f32_16x16x32_bf16 v[40:43], v[148:151], v[112:115], v[40:43]
    ds_read_b128 v[112:115], v6 offset:27648
    s_waitcnt lgkmcnt(10)
    v_mfma_f32_16x16x32_bf16 v[32:35], v[136:139], v[116:119], v[32:35]
    v_mfma_f32_16x16x32_bf16 v[36:39], v[140:143], v[116:119], v[36:39]
    buffer_load_dwordx4 v[180:183], v5, s[24:27], s67 offen offset:2048 sc1
    v_mfma_f32_16x16x32_bf16 v[40:43], v[144:147], v[116:119], v[40:43]
    v_mfma_f32_16x16x32_bf16 v[44:47], v[148:151], v[116:119], v[44:47]
    ds_read_b128 v[116:119], v6 offset:32256
    v_mfma_f32_16x16x32_bf16 v[36:39], v[136:139], v[120:123], v[36:39]
    v_mfma_f32_16x16x32_bf16 v[40:43], v[140:143], v[120:123], v[40:43]
    v_mfma_f32_16x16x32_bf16 v[44:47], v[144:147], v[120:123], v[44:47]
    v_mfma_f32_16x16x32_bf16 v[48:51], v[148:151], v[120:123], v[48:51]
    ds_read_b128 v[120:123], v6 offset:36864
    s_waitcnt lgkmcnt(10)
    v_mfma_f32_16x16x32_bf16 v[40:43], v[136:139], v[124:127], v[40:43]
    v_mfma_f32_16x16x32_bf16 v[44:47], v[140:143], v[124:127], v[44:47]
    v_mfma_f32_16x16x32_bf16 v[48:51], v[144:147], v[124:127], v[48:51]
    ds_read_b128 v[124:127], v6 offset:41472
    v_mfma_f32_16x16x32_bf16 v[44:47], v[136:139], v[128:131], v[44:47]
    v_mfma_f32_16x16x32_bf16 v[48:51], v[140:143], v[128:131], v[48:51]
    ds_read_b128 v[128:131], v6 offset:46080
    s_waitcnt lgkmcnt(11)
    v_mfma_f32_16x16x32_bf16 v[48:51], v[136:139], v[132:135], v[48:51]
    ds_read_b128 v[132:135], v6 offset:50688
    v_mov_b32 v6, v7
    s_waitcnt lgkmcnt(9) vmcnt(4)
    v_mfma_f32_16x16x32_bf16 v[16:19], v[164:167], v[88:91], v[16:19]
    ds_read_b128 v[88:91], v6 offset:0
    v_mfma_f32_16x16x32_bf16 v[16:19], v[160:163], v[92:95], v[16:19]
    s_add_u32 s76, s76, 32
    s_add_u32 s66, s66, 16384
    v_mfma_f32_16x16x32_bf16 v[20:23], v[164:167], v[92:95], v[20:23]
    ds_read_b128 v[92:95], v6 offset:4608
    v_mfma_f32_16x16x32_bf16 v[16:19], v[156:159], v[96:99], v[16:19]
    v_mfma_f32_16x16x32_bf16 v[20:23], v[160:163], v[96:99], v[20:23]
    s_add_u32 s67, s66, 4096
    v_mfma_f32_16x16x32_bf16 v[24:27], v[164:167], v[96:99], v[24:27]
    ds_read_b128 v[96:99], v6 offset:9216
    s_waitcnt lgkmcnt(10)
    v_mfma_f32_16x16x32_bf16 v[16:19], v[152:155], v[100:103], v[16:19]
    v_add_u32 v7, s76, v8
    v_mfma_f32_16x16x32_bf16 v[20:23], v[156:159], v[100:103], v[20:23]
    v_lshrrev_b32 v13, 2, v7
    v_mfma_f32_16x16x32_bf16 v[24:27], v[160:163], v[100:103], v[24:27]
    v_and_b32 v13, 64, v13
    v_mfma_f32_16x16x32_bf16 v[28:31], v[164:167], v[100:103], v[28:31]
    ds_read_b128 v[100:103], v6 offset:13824
    v_mfma_f32_16x16x32_bf16 v[20:23], v[152:155], v[104:107], v[20:23]
    v_xor_b32 v7, v7, v13
    v_mfma_f32_16x16x32_bf16 v[24:27], v[156:159], v[104:107], v[24:27]
    buffer_load_dwordx4 v[136:139], v5, s[24:27], s66 offen offset:0 sc1
    v_mfma_f32_16x16x32_bf16 v[28:31], v[160:163], v[104:107], v[28:31]
    v_mfma_f32_16x16x32_bf16 v[32:35], v[164:167], v[104:107], v[32:35]
    ds_read_b128 v[104:107], v6 offset:18432
    s_waitcnt lgkmcnt(10)
    v_mfma_f32_16x16x32_bf16 v[24:27], v[152:155], v[108:111], v[24:27]
    v_mfma_f32_16x16x32_bf16 v[28:31], v[156:159], v[108:111], v[28:31]
    buffer_load_dwordx4 v[140:143], v5, s[24:27], s66 offen offset:2048 sc1
    v_mfma_f32_16x16x32_bf16 v[32:35], v[160:163], v[108:111], v[32:35]
    v_mfma_f32_16x16x32_bf16 v[36:39], v[164:167], v[108:111], v[36:39]
    ds_read_b128 v[108:111], v6 offset:23040
    v_mfma_f32_16x16x32_bf16 v[28:31], v[152:155], v[112:115], v[28:31]
    v_mfma_f32_16x16x32_bf16 v[32:35], v[156:159], v[112:115], v[32:35]
    buffer_load_dwordx4 v[144:147], v5, s[24:27], s67 offen offset:0 sc1
    v_mfma_f32_16x16x32_bf16 v[36:39], v[160:163], v[112:115], v[36:39]
    v_mfma_f32_16x16x32_bf16 v[40:43], v[164:167], v[112:115], v[40:43]
    ds_read_b128 v[112:115], v6 offset:27648
    s_waitcnt lgkmcnt(10)
    v_mfma_f32_16x16x32_bf16 v[32:35], v[152:155], v[116:119], v[32:35]
    v_mfma_f32_16x16x32_bf16 v[36:39], v[156:159], v[116:119], v[36:39]
    buffer_load_dwordx4 v[148:151], v5, s[24:27], s67 offen offset:2048 sc1
    v_mfma_f32_16x16x32_bf16 v[40:43], v[160:163], v[116:119], v[40:43]
    v_mfma_f32_16x16x32_bf16 v[44:47], v[164:167], v[116:119], v[44:47]
    ds_read_b128 v[116:119], v6 offset:32256
    v_mfma_f32_16x16x32_bf16 v[36:39], v[152:155], v[120:123], v[36:39]
    v_mfma_f32_16x16x32_bf16 v[40:43], v[156:159], v[120:123], v[40:43]
    v_mfma_f32_16x16x32_bf16 v[44:47], v[160:163], v[120:123], v[44:47]
    v_mfma_f32_16x16x32_bf16 v[48:51], v[164:167], v[120:123], v[48:51]
    ds_read_b128 v[120:123], v6 offset:36864
    s_waitcnt lgkmcnt(10)
    v_mfma_f32_16x16x32_bf16 v[40:43], v[152:155], v[124:127], v[40:43]
    v_mfma_f32_16x16x32_bf16 v[44:47], v[156:159], v[124:127], v[44:47]
    v_mfma_f32_16x16x32_bf16 v[48:51], v[160:163], v[124:127], v[48:51]
    ds_read_b128 v[124:127], v6 offset:41472
    v_mfma_f32_16x16x32_bf16 v[44:47], v[152:155], v[128:131], v[44:47]
    v_mfma_f32_16x16x32_bf16 v[48:51], v[156:159], v[128:131], v[48:51]
    ds_read_b128 v[128:131], v6 offset:46080
    s_waitcnt lgkmcnt(11)
    v_mfma_f32_16x16x32_bf16 v[48:51], v[152:155], v[132:135], v[48:51]
    ds_read_b128 v[132:135], v6 offset:50688
    v_mov_b32 v6, v7
    s_waitcnt lgkmcnt(9) vmcnt(4)
    v_mfma_f32_16x16x32_bf16 v[16:19], v[180:183], v[88:91], v[16:19]
    ds_read_b128 v[88:91], v6 offset:0
    v_mfma_f32_16x16x32_bf16 v[16:19], v[176:179], v[92:95], v[16:19]
    s_add_u32 s76, s76, 32
    s_add_u32 s66, s66, 16384
    v_mfma_f32_16x16x32_bf16 v[20:23], v[180:183], v[92:95], v[20:23]
    ds_read_b128 v[92:95], v6 offset:4608
    v_mfma_f32_16x16x32_bf16 v[16:19], v[172:175], v[96:99], v[16:19]
    v_mfma_f32_16x16x32_bf16 v[20:23], v[176:179], v[96:99], v[20:23]
    s_add_u32 s67, s66, 4096
    v_mfma_f32_16x16x32_bf16 v[24:27], v[180:183], v[96:99], v[24:27]
    ds_read_b128 v[96:99], v6 offset:9216
    s_waitcnt lgkmcnt(10)
    v_mfma_f32_16x16x32_bf16 v[16:19], v[168:171], v[100:103], v[16:19]
    v_add_u32 v7, s76, v8
    v_mfma_f32_16x16x32_bf16 v[20:23], v[172:175], v[100:103], v[20:23]
    v_lshrrev_b32 v13, 2, v7
    v_mfma_f32_16x16x32_bf16 v[24:27], v[176:179], v[100:103], v[24:27]
    v_and_b32 v13, 64, v13
    v_mfma_f32_16x16x32_bf16 v[28:31], v[180:183], v[100:103], v[28:31]
    ds_read_b128 v[100:103], v6 offset:13824
    v_mfma_f32_16x16x32_bf16 v[20:23], v[168:171], v[104:107], v[20:23]
    v_xor_b32 v7, v7, v13
    v_mfma_f32_16x16x32_bf16 v[24:27], v[172:175], v[104:107], v[24:27]
    buffer_load_dwordx4 v[152:155], v5, s[24:27], s66 offen offset:0 sc1
    v_mfma_f32_16x16x32_bf16 v[28:31], v[176:179], v[104:107], v[28:31]
    v_mfma_f32_16x16x32_bf16 v[32:35], v[180:183], v[104:107], v[32:35]
    ds_read_b128 v[104:107], v6 offset:18432
    s_waitcnt lgkmcnt(10)
    v_mfma_f32_16x16x32_bf16 v[24:27], v[168:171], v[108:111], v[24:27]
    v_mfma_f32_16x16x32_bf16 v[28:31], v[172:175], v[108:111], v[28:31]
    buffer_load_dwordx4 v[156:159], v5, s[24:27], s66 offen offset:2048 sc1
    v_mfma_f32_16x16x32_bf16 v[32:35], v[176:179], v[108:111], v[32:35]
    v_mfma_f32_16x16x32_bf16 v[36:39], v[180:183], v[108:111], v[36:39]
    ds_read_b128 v[108:111], v6 offset:23040
    v_mfma_f32_16x16x32_bf16 v[28:31], v[168:171], v[112:115], v[28:31]
    v_mfma_f32_16x16x32_bf16 v[32:35], v[172:175], v[112:115], v[32:35]
    buffer_load_dwordx4 v[160:163], v5, s[24:27], s67 offen offset:0 sc1
    v_mfma_f32_16x16x32_bf16 v[36:39], v[176:179], v[112:115], v[36:39]
    v_mfma_f32_16x16x32_bf16 v[40:43], v[180:183], v[112:115], v[40:43]
    ds_read_b128 v[112:115], v6 offset:27648
    s_waitcnt lgkmcnt(10)
    v_mfma_f32_16x16x32_bf16 v[32:35], v[168:171], v[116:119], v[32:35]
    v_mfma_f32_16x16x32_bf16 v[36:39], v[172:175], v[116:119], v[36:39]
    buffer_load_dwordx4 v[164:167], v5, s[24:27], s67 offen offset:2048 sc1
    v_mfma_f32_16x16x32_bf16 v[40:43], v[176:179], v[116:119], v[40:43]
    v_mfma_f32_16x16x32_bf16 v[44:47], v[180:183], v[116:119], v[44:47]
    ds_read_b128 v[116:119], v6 offset:32256
    v_mfma_f32_16x16x32_bf16 v[36:39], v[168:171], v[120:123], v[36:39]
    v_mfma_f32_16x16x32_bf16 v[40:43], v[172:175], v[120:123], v[40:43]
    v_mfma_f32_16x16x32_bf16 v[44:47], v[176:179], v[120:123], v[44:47]
    v_mfma_f32_16x16x32_bf16 v[48:51], v[180:183], v[120:123], v[48:51]
    ds_read_b128 v[120:123], v6 offset:36864
    s_waitcnt lgkmcnt(10)
    v_mfma_f32_16x16x32_bf16 v[40:43], v[168:171], v[124:127], v[40:43]
    v_mfma_f32_16x16x32_bf16 v[44:47], v[172:175], v[124:127], v[44:47]
    v_mfma_f32_16x16x32_bf16 v[48:51], v[176:179], v[124:127], v[48:51]
    ds_read_b128 v[124:127], v6 offset:41472
    v_mfma_f32_16x16x32_bf16 v[44:47], v[168:171], v[128:131], v[44:47]
    v_mfma_f32_16x16x32_bf16 v[48:51], v[172:175], v[128:131], v[48:51]
    ds_read_b128 v[128:131], v6 offset:46080
    s_waitcnt lgkmcnt(11)
    v_mfma_f32_16x16x32_bf16 v[48:51], v[168:171], v[132:135], v[48:51]
    ds_read_b128 v[132:135], v6 offset:50688
    v_mov_b32 v6, v7
    s_add_u32 s72, s72, 1
    s_cmp_lt_u32 s72, 3
    s_cbranch_scc1 L_B2
    s_setprio 0
    s_waitcnt lgkmcnt(0)
    s_cmp_eq_u32 s73, 0
    s_cbranch_scc0 L_t_k1
    s_nop 5
    ds_write_b128 v200, v[20:23] offset:0
    ds_write_b128 v200, v[28:31] offset:1024
    ds_write_b128 v200, v[36:39] offset:2048
    ds_write_b128 v200, v[44:47] offset:3072
    v_mov_b32 v10, 1
    s_waitcnt lgkmcnt(0)
    ds_write_b32 v206, v10
    s_mov_b32 s81, 0
L_tp_k0:
    ds_read_b32 v11, v207
    s_add_u32 s81, s81, 1
    s_waitcnt lgkmcnt(0)
    v_readfirstlane_b32 s48, v11
    s_cmp_ge_u32 s81, 200000
    s_cbranch_scc1 L_td_k0
    s_cmp_eq_u32 s48, 0
    s_cbranch_scc1 L_tp_k0
L_td_k0:
    ds_read_b128 v[88:91], v201 offset:0
    ds_read_b128 v[92:95], v201 offset:1024
    ds_read_b128 v[96:99], v201 offset:2048
    ds_read_b128 v[100:103], v201 offset:3072
    ds_read_b128 v[104:107], v201 offset:4096
    s_waitcnt lgkmcnt(4)
    v_pk_add_f32 v[16:17], v[16:17], v[88:89]
    v_pk_add_f32 v[18:19], v[18:19], v[90:91]
    s_waitcnt lgkmcnt(3)
    v_pk_add_f32 v[24:25], v[24:25], v[92:93]
    v_pk_add_f32 v[26:27], v[26:27], v[94:95]
    s_waitcnt lgkmcnt(2)
    v_pk_add_f32 v[32:33], v[32:33], v[96:97]
    v_pk_add_f32 v[34:35], v[34:35], v[98:99]
    s_waitcnt lgkmcnt(1)
    v_pk_add_f32 v[40:41], v[40:41], v[100:101]
    v_pk_add_f32 v[42:43], v[42:43], v[102:103]
    s_waitcnt lgkmcnt(0)
    v_pk_add_f32 v[48:49], v[48:49], v[104:105]
    v_pk_add_f32 v[50:51], v[50:51], v[106:107]
    v_pk_mul_f32 v[16:17], v[16:17], s[84:85]
    v_pk_mul_f32 v[18:19], v[18:19], s[84:85]
    v_pk_mul_f32 v[24:25], v[24:25], s[84:85]
    v_pk_mul_f32 v[26:27], v[26:27], s[84:85]
    v_pk_mul_f32 v[32:33], v[32:33], s[84:85]
    v_pk_mul_f32 v[34:35], v[34:35], s[84:85]
    v_pk_mul_f32 v[40:41], v[40:41], s[84:85]
    v_pk_mul_f32 v[42:43], v[42:43], s[84:85]
    v_pk_mul_f32 v[48:49], v[48:49], s[84:85]
    v_pk_mul_f32 v[50:51], v[50:51], s[84:85]
    v_exp_f32 v16, v16
    v_exp_f32 v17, v17
    v_exp_f32 v18, v18
    v_exp_f32 v19, v19
    v_exp_f32 v24, v24
    v_exp_f32 v25, v25
    v_exp_f32 v26, v26
    v_exp_f32 v27, v27
    v_exp_f32 v32, v32
    v_exp_f32 v33, v33
    v_exp_f32 v34, v34
    v_exp_f32 v35, v35
    v_exp_f32 v40, v40
    v_exp_f32 v41, v41
    v_exp_f32 v42, v42
    v_exp_f32 v43, v43
    v_exp_f32 v48, v48
    v_exp_f32 v49, v49
    v_exp_f32 v50, v50
    v_exp_f32 v51, v51
    v_pk_add_f32 v[16:17], v[16:17], s[88:89]
    v_pk_add_f32 v[18:19], v[18:19], s[88:89]
    v_pk_add_f32 v[24:25], v[24:25], s[88:89]
    v_pk_add_f32 v[26:27], v[26:27], s[88:89]
    v_pk_add_f32 v[32:33], v[32:33], s[88:89]
    v_pk_add_f32 v[34:35], v[34:35], s[88:89]
    v_pk_add_f32 v[40:41], v[40:41], s[88:89]
    v_pk_add_f32 v[42:43], v[42:43], s[88:89]
    v_pk_add_f32 v[48:49], v[48:49], s[88:89]
    v_pk_add_f32 v[50:51], v[50:51], s[88:89]
    v_rcp_f32 v16, v16
    v_rcp_f32 v17, v17
    v_rcp_f32 v18, v18
    v_rcp_f32 v19, v19
    v_rcp_f32 v24, v24
    v_rcp_f32 v25, v25
    v_rcp_f32 v26, v26
    v_rcp_f32 v27, v27
    v_rcp_f32 v32, v32
    v_rcp_f32 v33, v33
    v_rcp_f32 v34, v34
    v_rcp_f32 v35, v35
    v_rcp_f32 v40, v40
    v_rcp_f32 v41, v41
    v_rcp_f32 v42, v42
    v_rcp_f32 v43, v43
    v_rcp_f32 v48, v48
    v_rcp_f32 v49, v49
    v_rcp_f32 v50, v50
    v_rcp_f32 v51, v51
    v_pk_fma_f32 v[16:17], v[16:17], s[86:87], v[204:205]
    v_pk_fma_f32 v[18:19], v[18:19], s[86:87], v[204:205]
    v_pk_fma_f32 v[24:25], v[24:25], s[86:87], v[204:205]
    v_pk_fma_f32 v[26:27], v[26:27], s[86:87], v[204:205]
    v_pk_fma_f32 v[32:33], v[32:33], s[86:87], v[204:205]
    v_pk_fma_f32 v[34:35], v[34:35], s[86:87], v[204:205]
    v_pk_fma_f32 v[40:41], v[40:41], s[86:87], v[204:205]
    v_pk_fma_f32 v[42:43], v[42:43], s[86:87], v[204:205]
    v_pk_fma_f32 v[48:49], v[48:49], s[86:87], v[204:205]
    v_pk_fma_f32 v[50:51], v[50:51], s[86:87], v[204:205]
    v_cvt_pk_bf16_f32 v52, v16, v17
    v_cvt_pk_bf16_f32 v53, v18, v19
    v_cvt_pk_bf16_f32 v54, v24, v25
    v_cvt_pk_bf16_f32 v55, v26, v27
    v_cvt_pk_bf16_f32 v56, v32, v33
    v_cvt_pk_bf16_f32 v57, v34, v35
    v_cvt_pk_bf16_f32 v58, v40, v41
    v_cvt_pk_bf16_f32 v59, v42, v43
    v_cvt_pk_bf16_f32 v60, v48, v49
    v_cvt_pk_bf16_f32 v61, v50, v51
    v_min_u32 v52, 0xfffffffe, v52
    v_min_u32 v53, 0xfffffffe, v53
    v_min_u32 v54, 0xfffffffe, v54
    v_min_u32 v55, 0xfffffffe, v55
    v_min_u32 v56, 0xfffffffe, v56
    v_min_u32 v57, 0xfffffffe, v57
    v_min_u32 v58, 0xfffffffe, v58
    v_min_u32 v59, 0xfffffffe, v59
    v_min_u32 v60, 0xfffffffe, v60
    v_min_u32 v61, 0xfffffffe, v61
    s_mov_b32 s49, 0
    buffer_store_dwordx2 v[52:53], v202, s[28:31], s49 offen sc1
    s_mov_b32 s49, 36864
    buffer_store_dwordx2 v[54:55], v202, s[28:31], s49 offen sc1
    s_mov_b32 s49, 73728
    buffer_store_dwordx2 v[56:57], v202, s[28:31], s49 offen sc1
    s_mov_b32 s49, 110592
    buffer_store_dwordx2 v[58:59], v202, s[28:31], s49 offen sc1
    s_mov_b32 s49, 147456
    buffer_store_dwordx2 v[60:61], v202, s[28:31], s49 offen sc1
    s_branch L_t_j
L_t_k1:
    s_nop 5
    ds_write_b128 v200, v[16:19] offset:0
    ds_write_b128 v200, v[24:27] offset:1024
    ds_write_b128 v200, v[32:35] offset:2048
    ds_write_b128 v200, v[40:43] offset:3072
    ds_write_b128 v200, v[48:51] offset:4096
    v_mov_b32 v10, 1
    s_waitcnt lgkmcnt(0)
    ds_write_b32 v206, v10
    s_mov_b32 s81, 0
L_tp_k1:
    ds_read_b32 v11, v207
    s_add_u32 s81, s81, 1
    s_waitcnt lgkmcnt(0)
    v_readfirstlane_b32 s48, v11
    s_cmp_ge_u32 s81, 200000
    s_cbranch_scc1 L_td_k1
    s_cmp_eq_u32 s48, 0
    s_cbranch_scc1 L_tp_k1
L_td_k1:
    ds_read_b128 v[88:91], v201 offset:0
    ds_read_b128 v[92:95], v201 offset:1024
    ds_read_b128 v[96:99], v201 offset:2048
    ds_read_b128 v[100:103], v201 offset:3072
    s_waitcnt lgkmcnt(3)
    v_pk_add_f32 v[20:21], v[20:21], v[88:89]
    v_pk_add_f32 v[22:23], v[22:23], v[90:91]
    s_waitcnt lgkmcnt(2)
    v_pk_add_f32 v[28:29], v[28:29], v[92:93]
    v_pk_add_f32 v[30:31], v[30:31], v[94:95]
    s_waitcnt lgkmcnt(1)
    v_pk_add_f32 v[36:37], v[36:37], v[96:97]
    v_pk_add_f32 v[38:39], v[38:39], v[98:99]
    s_waitcnt lgkmcnt(0)
    v_pk_add_f32 v[44:45], v[44:45], v[100:101]
    v_pk_add_f32 v[46:47], v[46:47], v[102:103]
    v_pk_mul_f32 v[20:21], v[20:21], s[84:85]
    v_pk_mul_f32 v[22:23], v[22:23], s[84:85]
    v_pk_mul_f32 v[28:29], v[28:29], s[84:85]
    v_pk_mul_f32 v[30:31], v[30:31], s[84:85]
    v_pk_mul_f32 v[36:37], v[36:37], s[84:85]
    v_pk_mul_f32 v[38:39], v[38:39], s[84:85]
    v_pk_mul_f32 v[44:45], v[44:45], s[84:85]
    v_pk_mul_f32 v[46:47], v[46:47], s[84:85]
    v_exp_f32 v20, v20
    v_exp_f32 v21, v21
    v_exp_f32 v22, v22
    v_exp_f32 v23, v23
    v_exp_f32 v28, v28
    v_exp_f32 v29, v29
    v_exp_f32 v30, v30
    v_exp_f32 v31, v31
    v_exp_f32 v36, v36
    v_exp_f32 v37, v37
    v_exp_f32 v38, v38
    v_exp_f32 v39, v39
    v_exp_f32 v44, v44
    v_exp_f32 v45, v45
    v_exp_f32 v46, v46
    v_exp_f32 v47, v47
    v_pk_add_f32 v[20:21], v[20:21], s[88:89]
    v_pk_add_f32 v[22:23], v[22:23], s[88:89]
    v_pk_add_f32 v[28:29], v[28:29], s[88:89]
    v_pk_add_f32 v[30:31], v[30:31], s[88:89]
    v_pk_add_f32 v[36:37], v[36:37], s[88:89]
    v_pk_add_f32 v[38:39], v[38:39], s[88:89]
    v_pk_add_f32 v[44:45], v[44:45], s[88:89]
    v_pk_add_f32 v[46:47], v[46:47], s[88:89]
    v_rcp_f32 v20, v20
    v_rcp_f32 v21, v21
    v_rcp_f32 v22, v22
    v_rcp_f32 v23, v23
    v_rcp_f32 v28, v28
    v_rcp_f32 v29, v29
    v_rcp_f32 v30, v30
    v_rcp_f32 v31, v31
    v_rcp_f32 v36, v36
    v_rcp_f32 v37, v37
    v_rcp_f32 v38, v38
    v_rcp_f32 v39, v39
    v_rcp_f32 v44, v44
    v_rcp_f32 v45, v45
    v_rcp_f32 v46, v46
    v_rcp_f32 v47, v47
    v_pk_fma_f32 v[20:21], v[20:21], s[86:87], v[204:205]
    v_pk_fma_f32 v[22:23], v[22:23], s[86:87], v[204:205]
    v_pk_fma_f32 v[28:29], v[28:29], s[86:87], v[204:205]
    v_pk_fma_f32 v[30:31], v[30:31], s[86:87], v[204:205]
    v_pk_fma_f32 v[36:37], v[36:37], s[86:87], v[204:205]
    v_pk_fma_f32 v[38:39], v[38:39], s[86:87], v[204:205]
    v_pk_fma_f32 v[44:45], v[44:45], s[86:87], v[204:205]
    v_pk_fma_f32 v[46:47], v[46:47], s[86:87], v[204:205]
    v_cvt_pk_bf16_f32 v52, v20, v21
    v_cvt_pk_bf16_f32 v53, v22, v23
    v_cvt_pk_bf16_f32 v54, v28, v29
    v_cvt_pk_bf16_f32 v55, v30, v31
    v_cvt_pk_bf16_f32 v56, v36, v37
    v_cvt_pk_bf16_f32 v57, v38, v39
    v_cvt_pk_bf16_f32 v58, v44, v45
    v_cvt_pk_bf16_f32 v59, v46, v47
    v_min_u32 v52, 0xfffffffe, v52
    v_min_u32 v53, 0xfffffffe, v53
    v_min_u32 v54, 0xfffffffe, v54
    v_min_u32 v55, 0xfffffffe, v55
    v_min_u32 v56, 0xfffffffe, v56
    v_min_u32 v57, 0xfffffffe, v57
    v_min_u32 v58, 0xfffffffe, v58
    v_min_u32 v59, 0xfffffffe, v59
    s_mov_b32 s49, 0
    buffer_store_dwordx2 v[52:53], v202, s[28:31], s49 offen sc1
    s_mov_b32 s49, 36864
    buffer_store_dwordx2 v[54:55], v202, s[28:31], s49 offen sc1
    s_mov_b32 s49, 73728
    buffer_store_dwordx2 v[56:57], v202, s[28:31], s49 offen sc1
    s_mov_b32 s49, 110592
    buffer_store_dwordx2 v[58:59], v202, s[28:31], s49 offen sc1
L_t_j:
    s_endpgm
L_helper:
    s_sub_u32 s68, s47, 4
    v_add_u32 v16, 0, v3
    v_add_u32 v17, 164864, v3
    v_add_u32 v18, 329728, v3
    v_add_u32 v19, 494592, v3
    s_mul_i32 s72, s68, 663552
    s_lshl_b32 s73, s68, 12
    s_add_u32 s73, s73, 101376
    v_bfe_u32 v24, v0, 1, 3
    v_lshlrev_b32 v24, 2, v24
    v_and_b32 v25, 1, v0
    v_add_u32 v24, v24, v25
    v_lshrrev_b32 v25, 5, v0
    v_lshl_add_u32 v24, v25, 1, v24
    v_mul_u32_u24 v20, 288, v24
    v_bfe_u32 v24, v0, 4, 1
    v_lshl_add_u32 v20, v24, 4, v20
    s_mul_i32 s48, s68, 9216
    v_add_u32 v20, s48, v20
    v_and_b32 v24, 15, v0
    v_lshlrev_b32 v24, 5, v24
    v_bfe_u32 v26, v0, 2, 1
    v_xor_b32 v26, v26, v25
    v_lshl_add_u32 v24, v26, 4, v24
    v_bfe_u32 v26, v0, 4, 1
    v_lshl_add_u32 v24, v26, 3, v24
    s_lshl_b32 s48, s68, 9
    s_add_u32 s48, s48, 150528
    v_add_u32 v21, s48, v24
    v_sub_u32 v23, 1, v25
    v_bfe_u32 v24, v0, 4, 1
    v_mul_u32_u24 v22, 544, v24
    v_bfe_u32 v24, v0, 2, 2
    v_lshl_add_u32 v22, v24, 6, v22
    v_and_b32 v24, 3, v0
    v_lshl_add_u32 v22, v24, 3, v22
    v_lshrrev_b32 v24, 3, v0
    v_lshrrev_b32 v26, 4, v0
    v_xor_b32 v24, v24, v26
    v_and_b32 v24, 1, v24
    v_and_b32 v26, 1, v0
    v_lshlrev_b32 v26, 4, v26
    v_mov_b32 v27, 0x3f80
    v_lshlrev_b32 v27, v26, v27
    v_lshlrev_b32 v28, 15, v25
    v_lshlrev_b32 v28, v26, v28
    v_or_b32 v28, v28, v27
    v_bfe_u32 v26, v0, 1, 2
    v_lshl_or_b32 v26, v24, 2, v26
    v_cmp_eq_u32 vcc, 0, v26
    s_nop 1
    v_cndmask_b32 v52, 0, v27, vcc
    v_cndmask_b32 v56, 0, v28, vcc
    v_cmp_eq_u32 vcc, 1, v26
    s_nop 1
    v_cndmask_b32 v53, 0, v27, vcc
    v_cndmask_b32 v57, 0, v28, vcc
    v_cmp_eq_u32 vcc, 2, v26
    s_nop 1
    v_cndmask_b32 v54, 0, v27, vcc
    v_cndmask_b32 v58, 0, v28, vcc
    v_cmp_eq_u32 vcc, 3, v26
    s_nop 1
    v_cndmask_b32 v55, 0, v27, vcc
    v_cndmask_b32 v59, 0, v28, vcc
    s_mov_b32 s88, s14
    s_and_b32 s89, s15, 0xffff
    s_mov_b32 s90, 9469952
    s_mov_b32 s91, 0x20000
    v_add_u32 v24, 0, v20
    v_lshrrev_b32 v25, 2, v24
    v_and_b32 v25, 64, v25
    v_xor_b32 v196, v24, v25
    v_add_u32 v24, 32, v20
    v_lshrrev_b32 v25, 2, v24
    v_and_b32 v25, 64, v25
    v_xor_b32 v197, v24, v25
    v_add_u32 v24, 64, v20
    v_lshrrev_b32 v25, 2, v24
    v_and_b32 v25, 64, v25
    v_xor_b32 v198, v24, v25
    v_add_u32 v24, 96, v20
    v_lshrrev_b32 v25, 2, v24
    v_and_b32 v25, 64, v25
    v_xor_b32 v199, v24, v25
    v_add_u32 v24, 128, v20
    v_lshrrev_b32 v25, 2, v24
    v_and_b32 v25, 64, v25
    v_xor_b32 v200, v24, v25
    v_add_u32 v24, 160, v20
    v_lshrrev_b32 v25, 2, v24
    v_and_b32 v25, 64, v25
    v_xor_b32 v201, v24, v25
    v_add_u32 v24, 192, v20
    v_lshrrev_b32 v25, 2, v24
    v_and_b32 v25, 64, v25
    v_xor_b32 v202, v24, v25
    v_add_u32 v24, 224, v20
    v_lshrrev_b32 v25, 2, v24
    v_and_b32 v25, 64, v25
    v_xor_b32 v203, v24, v25
    v_add_u32 v24, 256, v20
    v_lshrrev_b32 v25, 2, v24
    v_and_b32 v25, 64, v25
    v_xor_b32 v204, v24, v25
    v_mov_b32 v205, v21
    v_add_u32 v206, 5632, v21
    s_cmp_eq_u32 s68, 3
    s_cbranch_scc1 L_noprod
    s_waitcnt vmcnt(0)
    s_mul_i32 s57, s68, 5120
    s_add_u32 s57, s57, 134144
    v_lshlrev_b32 v24, 4, v0
    v_add_u32 v24, s57, v24
    ds_write_b128 v24, v[176:179] offset:0
    ds_write_b128 v24, v[180:183] offset:1024
    ds_write_b128 v24, v[184:187] offset:2048
    ds_write_b128 v24, v[188:191] offset:3072
    ds_write_b128 v24, v[192:195] offset:4096
    s_waitcnt lgkmcnt(0)
    v_mul_u32_u24 v26, 1024, v23
    v_sub_u32 v27, 1, v23
    v_mul_u32_u24 v27, 0, v27
    v_add3_u32 v26, v26, v27, v22
    v_add_u32 v26, s57, v26
    v_xor_b32 v27, 32, v26
    ds_read_b64_tr_b16 v[64:65], v26 offset:0
    ds_read_b64_tr_b16 v[66:67], v26 offset:256
    ds_read_b64_tr_b16 v[68:69], v27 offset:0
    ds_read_b64_tr_b16 v[70:71], v27 offset:256
    v_mul_u32_u24 v26, 2048, v23
    v_sub_u32 v27, 1, v23
    v_mul_u32_u24 v27, 0, v27
    v_add3_u32 v26, v26, v27, v22
    v_add_u32 v26, s57, v26
    v_xor_b32 v27, 32, v26
    ds_read_b64_tr_b16 v[80:81], v26 offset:0
    ds_read_b64_tr_b16 v[82:83], v26 offset:256
    ds_read_b64_tr_b16 v[84:85], v27 offset:0
    ds_read_b64_tr_b16 v[86:87], v27 offset:256
    v_mul_u32_u24 v26, 2048, v23
    v_sub_u32 v27, 1, v23
    v_mul_u32_u24 v27, 3072, v27
    v_add3_u32 v26, v26, v27, v22
    v_add_u32 v26, s57, v26
    v_xor_b32 v27, 32, v26
    ds_read_b64_tr_b16 v[72:73], v26 offset:0
    ds_read_b64_tr_b16 v[74:75], v26 offset:256
    ds_read_b64_tr_b16 v[76:77], v27 offset:0
    ds_read_b64_tr_b16 v[78:79], v27 offset:256
    v_mul_u32_u24 v26, 4096, v23
    v_sub_u32 v27, 1, v23
    v_mul_u32_u24 v27, 3072, v27
    v_add3_u32 v26, v26, v27, v22
    v_add_u32 v26, s57, v26
    v_xor_b32 v27, 32, v26
    ds_read_b64_tr_b16 v[88:89], v26 offset:0
    ds_read_b64_tr_b16 v[90:91], v26 offset:256
    ds_read_b64_tr_b16 v[92:93], v27 offset:0
    ds_read_b64_tr_b16 v[94:95], v27 offset:256
    s_waitcnt lgkmcnt(0)
    s_setprio 3
    v_mfma_f32_16x16x32_bf16 v[128:131], v[56:59], v[64:67], 0
    v_mfma_f32_16x16x32_bf16 v[132:135], v[56:59], v[68:71], 0
    v_mfma_f32_16x16x32_bf16 v[136:139], v[56:59], v[72:75], 0
    v_mfma_f32_16x16x32_bf16 v[140:143], v[56:59], v[76:79], 0
    v_mfma_f32_16x16x32_bf16 v[144:147], v[56:59], v[80:83], 0
    v_mfma_f32_16x16x32_bf16 v[148:151], v[56:59], v[84:87], 0
    v_mfma_f32_16x16x32_bf16 v[152:155], v[56:59], v[88:91], 0
    v_mfma_f32_16x16x32_bf16 v[156:159], v[56:59], v[92:95], 0
    s_setprio 0
    s_add_u32 s57, s53, s68
    s_and_b32 s58, s57, 1
    s_lshl_b32 s58, s58, 2
    s_lshr_b32 s57, s57, 1
    s_add_u32 s57, s57, s58
    s_lshl_b32 s58, s82, 3
    s_add_u32 s57, s57, s58
    s_lshl_b32 s57, s57, 11
    s_mul_i32 s58, s42, 147456
    s_add_u32 s57, s57, s58
    s_cmp_ge_u32 s68, s54
    s_cselect_b32 s57, 0x7f000000, s57
    s_add_u32 s58, s57, 1327104
    v_and_b32 v26, 15, v0
    v_lshlrev_b32 v26, 4, v26
    v_lshrrev_b32 v27, 5, v0
    v_lshl_add_u32 v26, v27, 8, v26
    v_bfe_u32 v27, v0, 4, 1
    v_lshl_add_u32 v26, v27, 3, v26
    v_mov_b32 v61, v26
    s_mov_b32 s62, s57
    s_mov_b32 s63, s58
    v_cvt_pk_bf16_f32 v160, v128, v129
    v_cvt_pk_bf16_f32 v161, v130, v131
    v_cvt_pk_bf16_f32 v162, v132, v133
    v_cvt_pk_bf16_f32 v163, v134, v135
    v_cvt_pk_bf16_f32 v164, v136, v137
    v_cvt_pk_bf16_f32 v165, v138, v139
    v_cvt_pk_bf16_f32 v166, v140, v141
    v_cvt_pk_bf16_f32 v167, v142, v143
    v_cvt_pk_bf16_f32 v168, v144, v145
    v_cvt_pk_bf16_f32 v169, v146, v147
    v_cvt_pk_bf16_f32 v170, v148, v149
    v_cvt_pk_bf16_f32 v171, v150, v151
    v_cvt_pk_bf16_f32 v172, v152, v153
    v_cvt_pk_bf16_f32 v173, v154, v155
    v_cvt_pk_bf16_f32 v174, v156, v157
    v_cvt_pk_bf16_f32 v175, v158, v159
    buffer_store_dwordx2 v[160:161], v61, s[24:27], s62 offen offset:0 sc1
    buffer_store_dwordx2 v[162:163], v61, s[24:27], s62 offen offset:1024 sc1
    buffer_store_dwordx2 v[164:165], v61, s[24:27], s62 offen offset:512 sc1
    buffer_store_dwordx2 v[166:167], v61, s[24:27], s62 offen offset:1536 sc1
    buffer_store_dwordx2 v[168:169], v61, s[24:27], s63 offen offset:0 sc1
    buffer_store_dwordx2 v[170:171], v61, s[24:27], s63 offen offset:1024 sc1
    buffer_store_dwordx2 v[172:173], v61, s[24:27], s63 offen offset:512 sc1
    buffer_store_dwordx2 v[174:175], v61, s[24:27], s63 offen offset:1536 sc1
L_noprod:
    s_barrier
    v_mov_b32 v26, 0
    s_cmp_lg_u32 s68, 3
    s_cbranch_scc1 L_H_n2
    buffer_load_dword v60, v26, s[84:87], 0 offen sc1
L_H_n2:
    ds_read_b128 v[28:31], v196
    ds_read_b128 v[32:35], v196 offset:36864
    v_add_u32 v25, 73728, v196
    ds_read_b128 v[36:39], v25
    s_waitcnt lgkmcnt(0)
    s_setprio 3
    v_mfma_f32_16x16x32_bf16 v[40:43], v[52:55], v[28:31], 0
    v_mfma_f32_16x16x32_bf16 v[44:47], v[52:55], v[32:35], 0
    v_mfma_f32_16x16x32_bf16 v[48:51], v[52:55], v[36:39], 0
    s_setprio 0
    s_nop 7
    v_cvt_pk_bf16_f32 v40, v40, v41
    v_cvt_pk_bf16_f32 v41, v42, v43
    ds_write_b64 v205, v[40:41] offset:0
    v_cvt_pk_bf16_f32 v44, v44, v45
    v_cvt_pk_bf16_f32 v45, v46, v47
    ds_write_b64 v205, v[44:45] offset:2048
    v_cvt_pk_bf16_f32 v48, v48, v49
    v_cvt_pk_bf16_f32 v49, v50, v51
    s_cmp_eq_u32 s68, 3
    s_cbranch_scc1 L_s3_0
    ds_write_b64 v205, v[48:49] offset:4096
L_s3_0:
    ds_read_b128 v[28:31], v197
    ds_read_b128 v[32:35], v197 offset:36864
    v_add_u32 v25, 73728, v197
    ds_read_b128 v[36:39], v25
    s_waitcnt lgkmcnt(0)
    s_setprio 3
    v_mfma_f32_16x16x32_bf16 v[40:43], v[52:55], v[28:31], 0
    v_mfma_f32_16x16x32_bf16 v[44:47], v[52:55], v[32:35], 0
    v_mfma_f32_16x16x32_bf16 v[48:51], v[52:55], v[36:39], 0
    s_setprio 0
    s_nop 7
    v_cvt_pk_bf16_f32 v40, v40, v41
    v_cvt_pk_bf16_f32 v41, v42, v43
    ds_write_b64 v206, v[40:41] offset:0
    v_cvt_pk_bf16_f32 v44, v44, v45
    v_cvt_pk_bf16_f32 v45, v46, v47
    ds_write_b64 v206, v[44:45] offset:2048
    v_cvt_pk_bf16_f32 v48, v48, v49
    v_cvt_pk_bf16_f32 v49, v50, v51
    s_cmp_eq_u32 s68, 3
    s_cbranch_scc1 L_s3_1
    ds_write_b64 v206, v[48:49] offset:4096
L_s3_1:
    ds_read_b128 v[28:31], v198
    ds_read_b128 v[32:35], v198 offset:36864
    v_add_u32 v25, 73728, v198
    ds_read_b128 v[36:39], v25
    s_waitcnt lgkmcnt(3)
    s_barrier
    v_mov_b32 v120, -1
    v_mov_b32 v121, -1
    v_mov_b32 v122, -1
    v_mov_b32 v123, -1
    s_mul_i32 s56, s43, 165888
    s_lshl_b32 s57, s42, 10
    s_add_u32 s56, s56, s57
    v_lshlrev_b32 v119, 4, v0
    v_add_u32 v119, s56, v119
    s_waitcnt vmcnt(0)
    s_cmp_lg_u32 s68, 3
    s_cbranch_scc1 L_H_n0
    s_mov_b32 s81, 0
L_H_nspin:
    v_readfirstlane_b32 s80, v60
    s_add_u32 s81, s81, 1
    s_cmp_lg_u32 s80, 0
    s_cbranch_scc1 L_H_n0
    s_cmp_ge_u32 s81, 200000
    s_cbranch_scc1 L_H_n0
    s_sleep 4
    v_mov_b32 v26, 0
    buffer_load_dword v60, v26, s[84:87], 0 offen sc1
    s_waitcnt vmcnt(0)
    s_branch L_H_nspin
L_H_n0:
    s_barrier
    s_mul_i32 s49, s42, 28
    s_add_u32 s49, s49, s43
    s_lshl_b32 s49, s49, 7
    s_add_u32 s49, s49, 9437184
    s_cmp_eq_u32 s68, 3
    s_cselect_b32 s49, s49, 0x7f000000
    v_mov_b32 v26, s49
    v_mov_b32 v27, s80
    s_mov_b64 exec, 1
    buffer_store_dword v27, v26, s[88:91], 0 offen sc1
    s_mov_b64 exec, -1
    s_waitcnt lgkmcnt(0)
    s_setprio 3
    v_mfma_f32_16x16x32_bf16 v[40:43], v[52:55], v[28:31], 0
    v_mfma_f32_16x16x32_bf16 v[44:47], v[52:55], v[32:35], 0
    v_mfma_f32_16x16x32_bf16 v[48:51], v[52:55], v[36:39], 0
    s_setprio 0
    s_add_u32 m0, s73, 0
    s_add_u32 s50, s72, 27648
    buffer_load_dwordx4 v16, s[20:23], s50 offen offset:0 lds
    buffer_load_dwordx4 v17, s[20:23], s50 offen offset:1024 lds
    buffer_load_dwordx4 v18, s[20:23], s50 offen offset:2048 lds
    buffer_load_dwordx4 v19, s[20:23], s50 offen offset:3072 lds
    s_nop 7
    v_cvt_pk_bf16_f32 v40, v40, v41
    v_cvt_pk_bf16_f32 v41, v42, v43
    ds_write_b64 v205, v[40:41] offset:0
    v_cvt_pk_bf16_f32 v44, v44, v45
    v_cvt_pk_bf16_f32 v45, v46, v47
    ds_write_b64 v205, v[44:45] offset:2048
    v_cvt_pk_bf16_f32 v48, v48, v49
    v_cvt_pk_bf16_f32 v49, v50, v51
    s_cmp_eq_u32 s68, 3
    s_cbranch_scc1 L_s3_2
    ds_write_b64 v205, v[48:49] offset:4096
L_s3_2:
    ds_read_b128 v[28:31], v199
    ds_read_b128 v[32:35], v199 offset:36864
    v_add_u32 v25, 73728, v199
    ds_read_b128 v[36:39], v25
    s_waitcnt lgkmcnt(3)
    s_barrier
    s_waitcnt lgkmcnt(0)
    s_setprio 3
    v_mfma_f32_16x16x32_bf16 v[40:43], v[52:55], v[28:31], 0
    v_mfma_f32_16x16x32_bf16 v[44:47], v[52:55], v[32:35], 0
    v_mfma_f32_16x16x32_bf16 v[48:51], v[52:55], v[36:39], 0
    s_setprio 0
    s_add_u32 m0, s73, 16384
    s_add_u32 s50, s72, 36864
    buffer_load_dwordx4 v16, s[20:23], s50 offen offset:0 lds
    buffer_load_dwordx4 v17, s[20:23], s50 offen offset:1024 lds
    buffer_load_dwordx4 v18, s[20:23], s50 offen offset:2048 lds
    buffer_load_dwordx4 v19, s[20:23], s50 offen offset:3072 lds
    s_nop 7
    v_cvt_pk_bf16_f32 v40, v40, v41
    v_cvt_pk_bf16_f32 v41, v42, v43
    ds_write_b64 v206, v[40:41] offset:0
    v_cvt_pk_bf16_f32 v44, v44, v45
    v_cvt_pk_bf16_f32 v45, v46, v47
    ds_write_b64 v206, v[44:45] offset:2048
    v_cvt_pk_bf16_f32 v48, v48, v49
    v_cvt_pk_bf16_f32 v49, v50, v51
    s_cmp_eq_u32 s68, 3
    s_cbranch_scc1 L_s3_3
    ds_write_b64 v206, v[48:49] offset:4096
L_s3_3:
    ds_read_b128 v[28:31], v200
    ds_read_b128 v[32:35], v200 offset:36864
    v_add_u32 v25, 73728, v200
    ds_read_b128 v[36:39], v25
    s_waitcnt vmcnt(4) lgkmcnt(3)
    s_barrier
    s_waitcnt lgkmcnt(0)
    s_setprio 3
    v_mfma_f32_16x16x32_bf16 v[40:43], v[52:55], v[28:31], 0
    v_mfma_f32_16x16x32_bf16 v[44:47], v[52:55], v[32:35], 0
    v_mfma_f32_16x16x32_bf16 v[48:51], v[52:55], v[36:39], 0
    s_setprio 0
    s_add_u32 m0, s73, 32768
    s_add_u32 s50, s72, 46080
    buffer_load_dwordx4 v16, s[20:23], s50 offen offset:0 lds
    buffer_load_dwordx4 v17, s[20:23], s50 offen offset:1024 lds
    buffer_load_dwordx4 v18, s[20:23], s50 offen offset:2048 lds
    buffer_load_dwordx4 v19, s[20:23], s50 offen offset:3072 lds
    s_nop 7
    v_cvt_pk_bf16_f32 v40, v40, v41
    v_cvt_pk_bf16_f32 v41, v42, v43
    ds_write_b64 v205, v[40:41] offset:0
    v_cvt_pk_bf16_f32 v44, v44, v45
    v_cvt_pk_bf16_f32 v45, v46, v47
    ds_write_b64 v205, v[44:45] offset:2048
    v_cvt_pk_bf16_f32 v48, v48, v49
    v_cvt_pk_bf16_f32 v49, v50, v51
    s_cmp_eq_u32 s68, 3
    s_cbranch_scc1 L_s3_4
    ds_write_b64 v205, v[48:49] offset:4096
L_s3_4:
    ds_read_b128 v[28:31], v201
    ds_read_b128 v[32:35], v201 offset:36864
    v_add_u32 v25, 73728, v201
    ds_read_b128 v[36:39], v25
    s_waitcnt vmcnt(4) lgkmcnt(3)
    s_barrier
    s_waitcnt lgkmcnt(0)
    s_setprio 3
    v_mfma_f32_16x16x32_bf16 v[40:43], v[52:55], v[28:31], 0
    v_mfma_f32_16x16x32_bf16 v[44:47], v[52:55], v[32:35], 0
    v_mfma_f32_16x16x32_bf16 v[48:51], v[52:55], v[36:39], 0
    s_setprio 0
    s_add_u32 m0, s73, 0
    s_add_u32 s50, s72, 55296
    buffer_load_dwordx4 v16, s[20:23], s50 offen offset:0 lds
    buffer_load_dwordx4 v17, s[20:23], s50 offen offset:1024 lds
    buffer_load_dwordx4 v18, s[20:23], s50 offen offset:2048 lds
    buffer_load_dwordx4 v19, s[20:23], s50 offen offset:3072 lds
    s_nop 7
    v_cvt_pk_bf16_f32 v40, v40, v41
    v_cvt_pk_bf16_f32 v41, v42, v43
    ds_write_b64 v206, v[40:41] offset:0
    v_cvt_pk_bf16_f32 v44, v44, v45
    v_cvt_pk_bf16_f32 v45, v46, v47
    ds_write_b64 v206, v[44:45] offset:2048
    v_cvt_pk_bf16_f32 v48, v48, v49
    v_cvt_pk_bf16_f32 v49, v50, v51
    s_cmp_eq_u32 s68, 3
    s_cbranch_scc1 L_s3_5
    ds_write_b64 v206, v[48:49] offset:4096
L_s3_5:
    ds_read_b128 v[28:31], v202
    ds_read_b128 v[32:35], v202 offset:36864
    v_add_u32 v25, 73728, v202
    ds_read_b128 v[36:39], v25
    s_waitcnt vmcnt(4) lgkmcnt(3)
    s_barrier
    s_waitcnt lgkmcnt(0)
    s_setprio 3
    v_mfma_f32_16x16x32_bf16 v[40:43], v[52:55], v[28:31], 0
    v_mfma_f32_16x16x32_bf16 v[44:47], v[52:55], v[32:35], 0
    v_mfma_f32_16x16x32_bf16 v[48:51], v[52:55], v[36:39], 0
    s_setprio 0
    s_add_u32 m0, s73, 16384
    s_add_u32 s50, s72, 64512
    buffer_load_dwordx4 v16, s[20:23], s50 offen offset:0 lds
    buffer_load_dwordx4 v17, s[20:23], s50 offen offset:1024 lds
    buffer_load_dwordx4 v18, s[20:23], s50 offen offset:2048 lds
    buffer_load_dwordx4 v19, s[20:23], s50 offen offset:3072 lds
    s_nop 7
    v_cvt_pk_bf16_f32 v40, v40, v41
    v_cvt_pk_bf16_f32 v41, v42, v43
    ds_write_b64 v205, v[40:41] offset:0
    v_cvt_pk_bf16_f32 v44, v44, v45
    v_cvt_pk_bf16_f32 v45, v46, v47
    ds_write_b64 v205, v[44:45] offset:2048
    v_cvt_pk_bf16_f32 v48, v48, v49
    v_cvt_pk_bf16_f32 v49, v50, v51
    s_cmp_eq_u32 s68, 3
    s_cbranch_scc1 L_s3_6
    ds_write_b64 v205, v[48:49] offset:4096
L_s3_6:
    ds_read_b128 v[28:31], v203
    ds_read_b128 v[32:35], v203 offset:36864
    v_add_u32 v25, 73728, v203
    ds_read_b128 v[36:39], v25
    s_waitcnt vmcnt(4) lgkmcnt(3)
    s_barrier
    s_waitcnt lgkmcnt(0)
    s_setprio 3
    v_mfma_f32_16x16x32_bf16 v[40:43], v[52:55], v[28:31], 0
    v_mfma_f32_16x16x32_bf16 v[44:47], v[52:55], v[32:35], 0
    v_mfma_f32_16x16x32_bf16 v[48:51], v[52:55], v[36:39], 0
    s_setprio 0
    s_add_u32 m0, s73, 32768
    s_add_u32 s50, s72, 73728
    buffer_load_dwordx4 v16, s[20:23], s50 offen offset:0 lds
    buffer_load_dwordx4 v17, s[20:23], s50 offen offset:1024 lds
    buffer_load_dwordx4 v18, s[20:23], s50 offen offset:2048 lds
    buffer_load_dwordx4 v19, s[20:23], s50 offen offset:3072 lds
    s_nop 7
    v_cvt_pk_bf16_f32 v40, v40, v41
    v_cvt_pk_bf16_f32 v41, v42, v43
    ds_write_b64 v206, v[40:41] offset:0
    v_cvt_pk_bf16_f32 v44, v44, v45
    v_cvt_pk_bf16_f32 v45, v46, v47
    ds_write_b64 v206, v[44:45] offset:2048
    v_cvt_pk_bf16_f32 v48, v48, v49
    v_cvt_pk_bf16_f32 v49, v50, v51
    s_cmp_eq_u32 s68, 3
    s_cbranch_scc1 L_s3_7
    ds_write_b64 v206, v[48:49] offset:4096
L_s3_7:
    ds_read_b128 v[28:31], v204
    ds_read_b128 v[32:35], v204 offset:36864
    v_add_u32 v25, 73728, v204
    ds_read_b128 v[36:39], v25
    s_waitcnt vmcnt(4) lgkmcnt(3)
    s_barrier
    v_min_u32 v63, 27, v0
    s_mul_i32 s48, s42, 28
    v_add_u32 v63, s48, v63
    v_lshlrev_b32 v63, 7, v63
    v_add_u32 v63, 9437184, v63
    s_cmp_lg_u32 s68, 3
    s_cbranch_scc1 L_H_np
    buffer_load_dword v124, v63, s[88:91], 0 offen sc1
L_H_np:
    s_waitcnt lgkmcnt(0)
    s_setprio 3
    v_mfma_f32_16x16x32_bf16 v[40:43], v[52:55], v[28:31], 0
    v_mfma_f32_16x16x32_bf16 v[44:47], v[52:55], v[32:35], 0
    v_mfma_f32_16x16x32_bf16 v[48:51], v[52:55], v[36:39], 0
    s_setprio 0
    s_nop 7
    v_cvt_pk_bf16_f32 v40, v40, v41
    v_cvt_pk_bf16_f32 v41, v42, v43
    ds_write_b64 v205, v[40:41] offset:0
    v_cvt_pk_bf16_f32 v44, v44, v45
    v_cvt_pk_bf16_f32 v45, v46, v47
    ds_write_b64 v205, v[44:45] offset:2048
    v_cvt_pk_bf16_f32 v48, v48, v49
    v_cvt_pk_bf16_f32 v49, v50, v51
    s_cmp_eq_u32 s68, 3
    s_cbranch_scc1 L_s3_8
    ds_write_b64 v205, v[48:49] offset:4096
L_s3_8:
    s_waitcnt vmcnt(0) lgkmcnt(0)
    s_cmp_lg_u32 s68, 3
    s_cbranch_scc1 L_H_f4
    s_mov_b32 s81, 0
L_H_fspin:
    v_cmp_ne_u32 vcc, s80, v124
    s_add_u32 s81, s81, 1
    s_cmp_ge_u32 s81, 200000
    s_cbranch_scc1 L_H_f4
    s_cbranch_vccz L_H_f4
    s_sleep 2
    buffer_load_dword v124, v63, s[88:91], 0 offen sc1
    s_waitcnt vmcnt(0)
    s_branch L_H_fspin
L_H_f4:
    s_barrier
    s_barrier
    v_lshlrev_b32 v24, 4, v0
    s_mov_b32 s50, s68
L_wo:
    s_lshl_b32 s51, s50, 10
    s_add_u32 m0, s51, 101376
    s_add_u32 s50, s50, 4
    buffer_load_dwordx4 v24, s[36:39], s51 offen lds
    s_sleep 2
    s_cmp_lt_u32 s50, 41
    s_cbranch_scc1 L_wo
    s_barrier
    s_add_u32 s57, s68, 0
    s_min_u32 s57, s57, 17
    s_mul_i32 s57, s57, 9216
    buffer_store_dwordx4 v[120:123], v119, s[28:31], s57 offen sc1
    s_sleep 2
    s_add_u32 s57, s68, 4
    s_min_u32 s57, s57, 17
    s_mul_i32 s57, s57, 9216
    buffer_store_dwordx4 v[120:123], v119, s[28:31], s57 offen sc1
    s_sleep 2
    s_add_u32 s57, s68, 8
    s_min_u32 s57, s57, 17
    s_mul_i32 s57, s57, 9216
    buffer_store_dwordx4 v[120:123], v119, s[28:31], s57 offen sc1
    s_sleep 2
    s_add_u32 s57, s68, 12
    s_min_u32 s57, s57, 17
    s_mul_i32 s57, s57, 9216
    buffer_store_dwordx4 v[120:123], v119, s[28:31], s57 offen sc1
    s_sleep 2
    s_add_u32 s57, s68, 16
    s_min_u32 s57, s57, 17
    s_mul_i32 s57, s57, 9216
    buffer_store_dwordx4 v[120:123], v119, s[28:31], s57 offen sc1
    s_sleep 2
    s_mul_i32 s48, s45, 1152000
    s_add_u32 s10, s10, s48
    s_addc_u32 s11, s11, 0
    s_mov_b32 s32, s10
    s_and_b32 s33, s11, 0xffff
    s_mov_b32 s34, 1152000
    s_mov_b32 s35, 0x20000
    s_waitcnt vmcnt(5)
    s_barrier
    v_lshrrev_b32 v24, 2, v0
    v_mul_u32_u24 v24, 288, v24
    v_and_b32 v25, 3, v0
    v_lshlrev_b32 v25, 3, v25
    v_add_u32 v24, v24, v25
    s_lshl_b32 s48, s68, 5
    s_add_u32 s48, s48, 101376
    v_add_u32 v24, s48, v24
    v_add_u32 v25, 256, v24
    ds_read_b64_tr_b16 v[64:65], v24 offset:0
    ds_read_b64_tr_b16 v[66:67], v24 offset:4608
    ds_read_b64_tr_b16 v[68:69], v24 offset:9216
    ds_read_b64_tr_b16 v[70:71], v24 offset:13824
    ds_read_b64_tr_b16 v[72:73], v24 offset:18432
    ds_read_b64_tr_b16 v[74:75], v24 offset:23040
    ds_read_b64_tr_b16 v[76:77], v24 offset:27648
    ds_read_b64_tr_b16 v[78:79], v24 offset:32256
    ds_read_b64_tr_b16 v[80:81], v24 offset:36864
    s_waitcnt lgkmcnt(0)
    ds_read_b64_tr_b16 v[82:83], v24 offset:128
    ds_read_b64_tr_b16 v[84:85], v24 offset:4736
    ds_read_b64_tr_b16 v[86:87], v24 offset:9344
    ds_read_b64_tr_b16 v[88:89], v24 offset:13952
    ds_read_b64_tr_b16 v[90:91], v24 offset:18560
    ds_read_b64_tr_b16 v[92:93], v24 offset:23168
    ds_read_b64_tr_b16 v[94:95], v24 offset:27776
    ds_read_b64_tr_b16 v[96:97], v24 offset:32384
    ds_read_b64_tr_b16 v[98:99], v24 offset:36992
    s_waitcnt lgkmcnt(0)
    ds_read_b64_tr_b16 v[100:101], v25 offset:0
    ds_read_b64_tr_b16 v[102:103], v25 offset:4608
    ds_read_b64_tr_b16 v[104:105], v25 offset:9216
    ds_read_b64_tr_b16 v[106:107], v25 offset:13824
    ds_read_b64_tr_b16 v[108:109], v25 offset:18432
    ds_read_b64_tr_b16 v[110:111], v25 offset:23040
    ds_read_b64_tr_b16 v[112:113], v25 offset:27648
    ds_read_b64_tr_b16 v[114:115], v25 offset:32256
    ds_read_b64_tr_b16 v[116:117], v25 offset:36864
    s_waitcnt lgkmcnt(0)
    v_bfe_u32 v41, v0, 1, 2
    v_lshlrev_b32 v41, 2, v41
    v_and_b32 v42, 1, v0
    v_add_u32 v41, v41, v42
    v_bfe_u32 v42, v0, 3, 1
    v_mul_u32_u24 v42, 144, v42
    v_add_u32 v41, v41, v42
    s_mul_i32 s48, s44, 288
    s_lshl_b32 s49, s42, 4
    s_add_u32 s48, s48, s49
    v_add_u32 v41, s48, v41
    v_mul_u32_u24 v41, 288, v41
    v_lshrrev_b32 v42, 4, v0
    v_lshlrev_b32 v42, 3, v42
    v_add_u32 v41, v41, v42
    s_lshl_b32 s48, s68, 5
    v_add_u32 v41, s48, v41
    s_and_b32 s76, s68, 1
    s_lshr_b32 s77, s68, 1
    s_lshl_b32 s48, s42, 1
    s_add_u32 s48, s48, s76
    s_cmp_lt_u32 s48, 9
    s_mov_b32 s78, 0xbfb8aa3b
    s_cselect_b32 s78, 0xc038aa3b, s78
    s_cselect_b32 s79, 2.0, 1.0
    s_cselect_b32 s49, -1.0, 0
    v_mov_b32 v43, s49
    s_mul_i32 s49, s43, 165888
    s_lshl_b32 s48, s48, 9
    s_add_u32 s48, s48, s49
    s_mul_i32 s49, s77, 18432
    s_add_u32 s48, s48, s49
    v_lshlrev_b32 v44, 3, v0
    v_add_u32 v44, s48, v44
    s_mul_i32 s48, s76, 9216
    s_lshl_b32 s49, s77, 10
    s_add_u32 s48, s48, s49
    s_add_u32 s48, s48, 101376
    v_lshlrev_b32 v45, 4, v0
    v_add_u32 v45, s48, v45
    v_and_b32 v24, 7, v0
    v_lshlrev_b32 v24, 2, v24
    v_add_u32 v24, 142336, v24
    v_mov_b32 v25, 0
    ds_write_b32 v24, v25
    s_waitcnt lgkmcnt(0)
    s_waitcnt vmcnt(0)
    s_barrier
    s_mul_i32 s49, s42, 28
    s_add_u32 s49, s49, s43
    s_lshl_b32 s49, s49, 7
    s_add_u32 s49, s49, 9437196
    s_cmp_eq_u32 s68, 3
    s_cselect_b32 s49, s49, 0x7f000000
    v_mov_b32 v26, s49
    v_mov_b32 v27, s80
    s_mov_b64 exec, 1
    buffer_store_dword v27, v26, s[88:91], 0 offen sc1
    s_mov_b64 exec, -1
    s_barrier
    ds_read_b128 v[128:131], v45 offset:0
    ds_read_b128 v[148:151], v45 offset:18432
    ds_read_b128 v[132:135], v45 offset:2048
    ds_read_b128 v[152:155], v45 offset:20480
    ds_read_b128 v[136:139], v45 offset:4096
    ds_read_b128 v[156:159], v45 offset:22528
    ds_read_b128 v[140:143], v45 offset:6144
    ds_read_b128 v[160:163], v45 offset:24576
    ds_read_b128 v[144:147], v45 offset:8192
    ds_read_b128 v[164:167], v45 offset:26624
    s_waitcnt lgkmcnt(8)
    v_add_f32 v128, v128, v148
    v_add_f32 v129, v129, v149
    v_add_f32 v130, v130, v150
    v_add_f32 v131, v131, v151
    s_waitcnt lgkmcnt(6)
    v_add_f32 v132, v132, v152
    v_add_f32 v133, v133, v153
    v_add_f32 v134, v134, v154
    v_add_f32 v135, v135, v155
    s_waitcnt lgkmcnt(4)
    v_add_f32 v136, v136, v156
    v_add_f32 v137, v137, v157
    v_add_f32 v138, v138, v158
    v_add_f32 v139, v139, v159
    s_waitcnt lgkmcnt(2)
    v_add_f32 v140, v140, v160
    v_add_f32 v141, v141, v161
    v_add_f32 v142, v142, v162
    v_add_f32 v143, v143, v163
    s_waitcnt lgkmcnt(0)
    v_add_f32 v144, v144, v164
    v_add_f32 v145, v145, v165
    v_add_f32 v146, v146, v166
    v_add_f32 v147, v147, v167
    v_mul_f32 v128, s78, v128
    v_mul_f32 v129, s78, v129
    v_mul_f32 v130, s78, v130
    v_mul_f32 v131, s78, v131
    v_mul_f32 v132, s78, v132
    v_mul_f32 v133, s78, v133
    v_mul_f32 v134, s78, v134
    v_mul_f32 v135, s78, v135
    v_mul_f32 v136, s78, v136
    v_mul_f32 v137, s78, v137
    v_mul_f32 v138, s78, v138
    v_mul_f32 v139, s78, v139
    v_mul_f32 v140, s78, v140
    v_mul_f32 v141, s78, v141
    v_mul_f32 v142, s78, v142
    v_mul_f32 v143, s78, v143
    v_mul_f32 v144, s78, v144
    v_mul_f32 v145, s78, v145
    v_mul_f32 v146, s78, v146
    v_mul_f32 v147, s78, v147
    v_exp_f32 v128, v128
    v_exp_f32 v129, v129
    v_exp_f32 v130, v130
    v_exp_f32 v131, v131
    v_exp_f32 v132, v132
    v_exp_f32 v133, v133
    v_exp_f32 v134, v134
    v_exp_f32 v135, v135
    v_exp_f32 v136, v136
    v_exp_f32 v137, v137
    v_exp_f32 v138, v138
    v_exp_f32 v139, v139
    v_exp_f32 v140, v140
    v_exp_f32 v141, v141
    v_exp_f32 v142, v142
    v_exp_f32 v143, v143
    v_exp_f32 v144, v144
    v_exp_f32 v145, v145
    v_exp_f32 v146, v146
    v_exp_f32 v147, v147
    v_add_f32 v128, 1.0, v128
    v_add_f32 v129, 1.0, v129
    v_add_f32 v130, 1.0, v130
    v_add_f32 v131, 1.0, v131
    v_add_f32 v132, 1.0, v132
    v_add_f32 v133, 1.0, v133
    v_add_f32 v134, 1.0, v134
    v_add_f32 v135, 1.0, v135
    v_add_f32 v136, 1.0, v136
    v_add_f32 v137, 1.0, v137
    v_add_f32 v138, 1.0, v138
    v_add_f32 v139, 1.0, v139
    v_add_f32 v140, 1.0, v140
    v_add_f32 v141, 1.0, v141
    v_add_f32 v142, 1.0, v142
    v_add_f32 v143, 1.0, v143
    v_add_f32 v144, 1.0, v144
    v_add_f32 v145, 1.0, v145
    v_add_f32 v146, 1.0, v146
    v_add_f32 v147, 1.0, v147
    v_rcp_f32 v128, v128
    v_rcp_f32 v129, v129
    v_rcp_f32 v130, v130
    v_rcp_f32 v131, v131
    v_rcp_f32 v132, v132
    v_rcp_f32 v133, v133
    v_rcp_f32 v134, v134
    v_rcp_f32 v135, v135
    v_rcp_f32 v136, v136
    v_rcp_f32 v137, v137
    v_rcp_f32 v138, v138
    v_rcp_f32 v139, v139
    v_rcp_f32 v140, v140
    v_rcp_f32 v141, v141
    v_rcp_f32 v142, v142
    v_rcp_f32 v143, v143
    v_rcp_f32 v144, v144
    v_rcp_f32 v145, v145
    v_rcp_f32 v146, v146
    v_rcp_f32 v147, v147
    s_nop 0
    v_fma_f32 v128, v128, s79, v43
    v_fma_f32 v129, v129, s79, v43
    v_fma_f32 v130, v130, s79, v43
    v_fma_f32 v131, v131, s79, v43
    v_fma_f32 v132, v132, s79, v43
    v_fma_f32 v133, v133, s79, v43
    v_fma_f32 v134, v134, s79, v43
    v_fma_f32 v135, v135, s79, v43
    v_fma_f32 v136, v136, s79, v43
    v_fma_f32 v137, v137, s79, v43
    v_fma_f32 v138, v138, s79, v43
    v_fma_f32 v139, v139, s79, v43
    v_fma_f32 v140, v140, s79, v43
    v_fma_f32 v141, v141, s79, v43
    v_fma_f32 v142, v142, s79, v43
    v_fma_f32 v143, v143, s79, v43
    v_fma_f32 v144, v144, s79, v43
    v_fma_f32 v145, v145, s79, v43
    v_fma_f32 v146, v146, s79, v43
    v_fma_f32 v147, v147, s79, v43
    v_cvt_pk_bf16_f32 v20, v128, v129
    v_cvt_pk_bf16_f32 v21, v130, v131
    v_cvt_pk_bf16_f32 v22, v132, v133
    v_cvt_pk_bf16_f32 v23, v134, v135
    v_cvt_pk_bf16_f32 v24, v136, v137
    v_cvt_pk_bf16_f32 v25, v138, v139
    v_cvt_pk_bf16_f32 v26, v140, v141
    v_cvt_pk_bf16_f32 v27, v142, v143
    v_cvt_pk_bf16_f32 v28, v144, v145
    v_cvt_pk_bf16_f32 v29, v146, v147
    v_min_u32 v20, 0xfffffffe, v20
    v_min_u32 v21, 0xfffffffe, v21
    v_min_u32 v22, 0xfffffffe, v22
    v_min_u32 v23, 0xfffffffe, v23
    v_min_u32 v24, 0xfffffffe, v24
    v_min_u32 v25, 0xfffffffe, v25
    v_min_u32 v26, 0xfffffffe, v26
    v_min_u32 v27, 0xfffffffe, v27
    v_min_u32 v28, 0xfffffffe, v28
    v_min_u32 v29, 0xfffffffe, v29
    s_mov_b32 s49, 0
    buffer_store_dwordx2 v[20:21], v44, s[28:31], s49 offen sc1
    s_mov_b32 s49, 36864
    buffer_store_dwordx2 v[22:23], v44, s[28:31], s49 offen sc1
    s_mov_b32 s49, 73728
    buffer_store_dwordx2 v[24:25], v44, s[28:31], s49 offen sc1
    s_mov_b32 s49, 110592
    buffer_store_dwordx2 v[26:27], v44, s[28:31], s49 offen sc1
    s_cmp_eq_u32 s77, 1
    s_cbranch_scc1 L_y0_done
    s_mov_b32 s49, 147456
    buffer_store_dwordx2 v[28:29], v44, s[28:31], s49 offen sc1
L_y0_done:
    v_mul_u32_u24 v62, 28, v0
    v_add_u32 v62, s43, v62
    v_lshlrev_b32 v62, 7, v62
    v_add_u32 v62, 9437196, v62
    s_cmp_lg_u32 s68, 3
    s_cbranch_scc1 L_fbs
    s_mov_b32 s81, 0
    s_mov_b64 exec, 0x1ff
L_fb:
    buffer_load_dword v61, v62, s[88:91], 0 offen sc1
    s_add_u32 s81, s81, 1
    s_waitcnt vmcnt(0)
    v_cmp_ne_u32 vcc, s80, v61
    s_cmp_ge_u32 s81, 200000
    s_cbranch_scc1 L_fbd
    s_cbranch_vccz L_fbd
    s_sleep 4
    s_branch L_fb
L_fbd:
    s_mov_b64 exec, -1
L_fbs:
    v_mov_b32 v24, 142344
    v_mov_b32 v25, 1
    s_cmp_lg_u32 s68, 3
    s_cbranch_scc1 L_fbw
    ds_write_b32 v24, v25
L_fbw:
    s_mov_b32 s81, 0
L_fbr:
    ds_read_b32 v25, v24
    s_add_u32 s81, s81, 1
    s_waitcnt lgkmcnt(0)
    v_readfirstlane_b32 s48, v25
    s_cmp_ge_u32 s81, 200000
    s_cbranch_scc1 L_fbrd
    s_cmp_eq_u32 s48, 0
    s_cbranch_scc0 L_fbrd
    s_sleep 2
    s_branch L_fbr
L_fbrd:
    s_mul_i32 s48, s43, 165888
    s_mul_i32 s49, s42, 18432
    s_add_u32 s48, s48, s49
    s_add_u32 s48, s48, 0
    v_lshlrev_b32 v14, 3, v0
    v_add_u32 v14, s48, v14
    v_lshlrev_b32 v15, 4, v0
    v_add_u32 v15, 158720, v15
    s_add_u32 s60, s68, 4
    s_cmp_eq_u32 s68, 0
    s_cselect_b32 s61, 8, s68
    s_sleep 20
    s_lshl_b32 s50, s68, 9
    s_add_u32 s51, s50, 4608
    s_lshl_b32 s52, s60, 9
    s_add_u32 s53, s52, 4608
    s_lshl_b32 s54, s61, 9
    s_add_u32 s55, s54, 4608
    s_mov_b32 s81, 0
L_zp_q0:
    buffer_load_dwordx2 v[128:129], v14, s[28:31], s50 offen sc1
    buffer_load_dwordx2 v[130:131], v14, s[28:31], s51 offen sc1
    buffer_load_dwordx2 v[132:133], v14, s[28:31], s52 offen sc1
    buffer_load_dwordx2 v[134:135], v14, s[28:31], s53 offen sc1
    buffer_load_dwordx2 v[136:137], v14, s[28:31], s54 offen sc1
    buffer_load_dwordx2 v[138:139], v14, s[28:31], s55 offen sc1
    s_add_u32 s81, s81, 1
    s_waitcnt vmcnt(0)
    v_max_u32 v150, v128, v129
    v_max3_u32 v150, v150, v130, v131
    v_max3_u32 v150, v150, v132, v133
    v_max3_u32 v150, v150, v134, v135
    v_max3_u32 v150, v150, v136, v137
    v_max3_u32 v150, v150, v138, v139
    v_cmp_eq_u32 vcc, -1, v150
    s_cmp_ge_u32 s81, 200000
    s_cbranch_scc1 L_zd_q0
    s_cbranch_vccz L_zd_q0
    s_sleep 12
    s_branch L_zp_q0
L_zd_q0:
    v_lshlrev_b32 v146, 16, v128
    v_lshlrev_b32 v147, 16, v130
    v_and_b32 v148, 0xffff0000, v128
    v_and_b32 v149, 0xffff0000, v130
    v_mul_f32 v146, v146, v147
    v_mul_f32 v148, v148, v149
    v_cvt_pk_bf16_f32 v140, v146, v148
    v_lshlrev_b32 v146, 16, v129
    v_lshlrev_b32 v147, 16, v131
    v_and_b32 v148, 0xffff0000, v129
    v_and_b32 v149, 0xffff0000, v131
    v_mul_f32 v146, v146, v147
    v_mul_f32 v148, v148, v149
    v_cvt_pk_bf16_f32 v141, v146, v148
    s_lshr_b32 s48, s68, 1
    s_lshl_b32 s48, s48, 10
    s_and_b32 s49, s68, 1
    s_lshl_b32 s49, s49, 3
    s_add_u32 s48, s48, s49
    v_add_u32 v150, s48, v15
    ds_write_b64 v150, v[140:141]
    v_lshlrev_b32 v146, 16, v132
    v_lshlrev_b32 v147, 16, v134
    v_and_b32 v148, 0xffff0000, v132
    v_and_b32 v149, 0xffff0000, v134
    v_mul_f32 v146, v146, v147
    v_mul_f32 v148, v148, v149
    v_cvt_pk_bf16_f32 v142, v146, v148
    v_lshlrev_b32 v146, 16, v133
    v_lshlrev_b32 v147, 16, v135
    v_and_b32 v148, 0xffff0000, v133
    v_and_b32 v149, 0xffff0000, v135
    v_mul_f32 v146, v146, v147
    v_mul_f32 v148, v148, v149
    v_cvt_pk_bf16_f32 v143, v146, v148
    s_lshr_b32 s48, s60, 1
    s_lshl_b32 s48, s48, 10
    s_and_b32 s49, s60, 1
    s_lshl_b32 s49, s49, 3
    s_add_u32 s48, s48, s49
    v_add_u32 v150, s48, v15
    ds_write_b64 v150, v[142:143]
    v_lshlrev_b32 v146, 16, v136
    v_lshlrev_b32 v147, 16, v138
    v_and_b32 v148, 0xffff0000, v136
    v_and_b32 v149, 0xffff0000, v138
    v_mul_f32 v146, v146, v147
    v_mul_f32 v148, v148, v149
    v_cvt_pk_bf16_f32 v144, v146, v148
    v_lshlrev_b32 v146, 16, v137
    v_lshlrev_b32 v147, 16, v139
    v_and_b32 v148, 0xffff0000, v137
    v_and_b32 v149, 0xffff0000, v139
    v_mul_f32 v146, v146, v147
    v_mul_f32 v148, v148, v149
    v_cvt_pk_bf16_f32 v145, v146, v148
    s_lshr_b32 s48, s61, 1
    s_lshl_b32 s48, s48, 10
    s_and_b32 s49, s61, 1
    s_lshl_b32 s49, s49, 3
    s_add_u32 s48, s48, s49
    v_add_u32 v150, s48, v15
    ds_write_b64 v150, v[144:145]
    s_waitcnt lgkmcnt(0)
    v_mov_b32 v24, 142336
    v_mov_b32 v25, 1
    s_mov_b64 exec, 1
    ds_add_u32 v24, v25
    s_mov_b64 exec, -1
    s_mov_b32 s81, 0
L_q0c:
    ds_read_b32 v25, v24
    s_add_u32 s81, s81, 1
    s_waitcnt lgkmcnt(0)
    v_readfirstlane_b32 s48, v25
    s_cmp_ge_u32 s81, 200000
    s_cbranch_scc1 L_q0cd
    s_cmp_lt_u32 s48, 4
    s_cbranch_scc1 L_q0c
L_q0cd:
    ds_read_b128 v[160:163], v15 offset:0
    ds_read_b128 v[164:167], v15 offset:1024
    ds_read_b128 v[168:171], v15 offset:2048
    ds_read_b128 v[172:175], v15 offset:3072
    ds_read_b64 v[176:177], v15 offset:4096
    s_waitcnt lgkmcnt(0)
    s_setprio 3
    v_mfma_f32_16x16x32_bf16 v[20:23], v[64:67], v[160:163], 0
    v_mfma_f32_16x16x32_bf16 v[24:27], v[82:85], v[160:163], 0
    v_mfma_f32_16x16x32_bf16 v[28:31], v[100:103], v[160:163], 0
    v_mfma_f32_16x16x32_bf16 v[20:23], v[68:71], v[164:167], v[20:23]
    v_mfma_f32_16x16x32_bf16 v[24:27], v[86:89], v[164:167], v[24:27]
    v_mfma_f32_16x16x32_bf16 v[28:31], v[104:107], v[164:167], v[28:31]
    v_mfma_f32_16x16x32_bf16 v[20:23], v[72:75], v[168:171], v[20:23]
    v_mfma_f32_16x16x32_bf16 v[24:27], v[90:93], v[168:171], v[24:27]
    v_mfma_f32_16x16x32_bf16 v[28:31], v[108:111], v[168:171], v[28:31]
    v_mfma_f32_16x16x32_bf16 v[20:23], v[76:79], v[172:175], v[20:23]
    v_mfma_f32_16x16x32_bf16 v[24:27], v[94:97], v[172:175], v[24:27]
    v_mfma_f32_16x16x32_bf16 v[28:31], v[112:115], v[172:175], v[28:31]
    s_nop 7
    v_mfma_f32_16x16x16_bf16 v[20:23], v[80:81], v[176:177], v[20:23]
    v_mfma_f32_16x16x16_bf16 v[24:27], v[98:99], v[176:177], v[24:27]
    v_mfma_f32_16x16x16_bf16 v[28:31], v[116:117], v[176:177], v[28:31]
    s_setprio 0
    s_nop 7
    v_cvt_pk_bf16_f32 v32, v20, v21
    v_cvt_pk_bf16_f32 v33, v22, v23
    buffer_store_dwordx2 v[32:33], v41, s[32:35], 0 offen offset:0
    v_cvt_pk_bf16_f32 v34, v24, v25
    v_cvt_pk_bf16_f32 v35, v26, v27
    buffer_store_dwordx2 v[34:35], v41, s[32:35], 0 offen offset:128
    s_cmp_lg_u32 s68, 0
    s_cbranch_scc1 L_pj_q0
    v_cvt_pk_bf16_f32 v36, v28, v29
    v_cvt_pk_bf16_f32 v37, v30, v31
    buffer_store_dwordx2 v[36:37], v41, s[32:35], 0 offen offset:256
L_pj_q0:
    s_mul_i32 s48, s43, 165888
    s_mul_i32 s49, s42, 18432
    s_add_u32 s48, s48, s49
    s_add_u32 s48, s48, 9216
    v_lshlrev_b32 v14, 3, v0
    v_add_u32 v14, s48, v14
    v_lshlrev_b32 v15, 4, v0
    v_add_u32 v15, 101376, v15
    s_add_u32 s60, s68, 4
    s_cmp_eq_u32 s68, 0
    s_cselect_b32 s61, 8, s68
    s_lshl_b32 s50, s68, 9
    s_add_u32 s51, s50, 4608
    s_lshl_b32 s52, s60, 9
    s_add_u32 s53, s52, 4608
    s_lshl_b32 s54, s61, 9
    s_add_u32 s55, s54, 4608
    s_mov_b32 s81, 0
L_zp_q1:
    buffer_load_dwordx2 v[128:129], v14, s[28:31], s50 offen sc1
    buffer_load_dwordx2 v[130:131], v14, s[28:31], s51 offen sc1
    buffer_load_dwordx2 v[132:133], v14, s[28:31], s52 offen sc1
    buffer_load_dwordx2 v[134:135], v14, s[28:31], s53 offen sc1
    buffer_load_dwordx2 v[136:137], v14, s[28:31], s54 offen sc1
    buffer_load_dwordx2 v[138:139], v14, s[28:31], s55 offen sc1
    s_add_u32 s81, s81, 1
    s_waitcnt vmcnt(0)
    v_max_u32 v150, v128, v129
    v_max3_u32 v150, v150, v130, v131
    v_max3_u32 v150, v150, v132, v133
    v_max3_u32 v150, v150, v134, v135
    v_max3_u32 v150, v150, v136, v137
    v_max3_u32 v150, v150, v138, v139
    v_cmp_eq_u32 vcc, -1, v150
    s_cmp_ge_u32 s81, 200000
    s_cbranch_scc1 L_zd_q1
    s_cbranch_vccz L_zd_q1
    s_sleep 2
    s_branch L_zp_q1
L_zd_q1:
    v_lshlrev_b32 v146, 16, v128
    v_lshlrev_b32 v147, 16, v130
    v_and_b32 v148, 0xffff0000, v128
    v_and_b32 v149, 0xffff0000, v130
    v_mul_f32 v146, v146, v147
    v_mul_f32 v148, v148, v149
    v_cvt_pk_bf16_f32 v140, v146, v148
    v_lshlrev_b32 v146, 16, v129
    v_lshlrev_b32 v147, 16, v131
    v_and_b32 v148, 0xffff0000, v129
    v_and_b32 v149, 0xffff0000, v131
    v_mul_f32 v146, v146, v147
    v_mul_f32 v148, v148, v149
    v_cvt_pk_bf16_f32 v141, v146, v148
    s_lshr_b32 s48, s68, 1
    s_lshl_b32 s48, s48, 10
    s_and_b32 s49, s68, 1
    s_lshl_b32 s49, s49, 3
    s_add_u32 s48, s48, s49
    v_add_u32 v150, s48, v15
    ds_write_b64 v150, v[140:141]
    v_lshlrev_b32 v146, 16, v132
    v_lshlrev_b32 v147, 16, v134
    v_and_b32 v148, 0xffff0000, v132
    v_and_b32 v149, 0xffff0000, v134
    v_mul_f32 v146, v146, v147
    v_mul_f32 v148, v148, v149
    v_cvt_pk_bf16_f32 v142, v146, v148
    v_lshlrev_b32 v146, 16, v133
    v_lshlrev_b32 v147, 16, v135
    v_and_b32 v148, 0xffff0000, v133
    v_and_b32 v149, 0xffff0000, v135
    v_mul_f32 v146, v146, v147
    v_mul_f32 v148, v148, v149
    v_cvt_pk_bf16_f32 v143, v146, v148
    s_lshr_b32 s48, s60, 1
    s_lshl_b32 s48, s48, 10
    s_and_b32 s49, s60, 1
    s_lshl_b32 s49, s49, 3
    s_add_u32 s48, s48, s49
    v_add_u32 v150, s48, v15
    ds_write_b64 v150, v[142:143]
    v_lshlrev_b32 v146, 16, v136
    v_lshlrev_b32 v147, 16, v138
    v_and_b32 v148, 0xffff0000, v136
    v_and_b32 v149, 0xffff0000, v138
    v_mul_f32 v146, v146, v147
    v_mul_f32 v148, v148, v149
    v_cvt_pk_bf16_f32 v144, v146, v148
    v_lshlrev_b32 v146, 16, v137
    v_lshlrev_b32 v147, 16, v139
    v_and_b32 v148, 0xffff0000, v137
    v_and_b32 v149, 0xffff0000, v139
    v_mul_f32 v146, v146, v147
    v_mul_f32 v148, v148, v149
    v_cvt_pk_bf16_f32 v145, v146, v148
    s_lshr_b32 s48, s61, 1
    s_lshl_b32 s48, s48, 10
    s_and_b32 s49, s61, 1
    s_lshl_b32 s49, s49, 3
    s_add_u32 s48, s48, s49
    v_add_u32 v150, s48, v15
    ds_write_b64 v150, v[144:145]
    s_waitcnt lgkmcnt(0)
    v_mov_b32 v24, 142340
    v_mov_b32 v25, 1
    s_mov_b64 exec, 1
    ds_add_u32 v24, v25
    s_mov_b64 exec, -1
    s_mov_b32 s81, 0
L_q1c:
    ds_read_b32 v25, v24
    s_add_u32 s81, s81, 1
    s_waitcnt lgkmcnt(0)
    v_readfirstlane_b32 s48, v25
    s_cmp_ge_u32 s81, 200000
    s_cbranch_scc1 L_q1cd
    s_cmp_lt_u32 s48, 4
    s_cbranch_scc1 L_q1c
L_q1cd:
    ds_read_b128 v[160:163], v15 offset:0
    ds_read_b128 v[164:167], v15 offset:1024
    ds_read_b128 v[168:171], v15 offset:2048
    ds_read_b128 v[172:175], v15 offset:3072
    ds_read_b64 v[176:177], v15 offset:4096
    s_waitcnt lgkmcnt(0)
    s_setprio 3
    v_mfma_f32_16x16x32_bf16 v[20:23], v[64:67], v[160:163], 0
    v_mfma_f32_16x16x32_bf16 v[24:27], v[82:85], v[160:163], 0
    v_mfma_f32_16x16x32_bf16 v[28:31], v[100:103], v[160:163], 0
    v_mfma_f32_16x16x32_bf16 v[20:23], v[68:71], v[164:167], v[20:23]
    v_mfma_f32_16x16x32_bf16 v[24:27], v[86:89], v[164:167], v[24:27]
    v_mfma_f32_16x16x32_bf16 v[28:31], v[104:107], v[164:167], v[28:31]
    v_mfma_f32_16x16x32_bf16 v[20:23], v[72:75], v[168:171], v[20:23]
    v_mfma_f32_16x16x32_bf16 v[24:27], v[90:93], v[168:171], v[24:27]
    v_mfma_f32_16x16x32_bf16 v[28:31], v[108:111], v[168:171], v[28:31]
    v_mfma_f32_16x16x32_bf16 v[20:23], v[76:79], v[172:175], v[20:23]
    v_mfma_f32_16x16x32_bf16 v[24:27], v[94:97], v[172:175], v[24:27]
    v_mfma_f32_16x16x32_bf16 v[28:31], v[112:115], v[172:175], v[28:31]
    s_nop 7
    v_mfma_f32_16x16x16_bf16 v[20:23], v[80:81], v[176:177], v[20:23]
    v_mfma_f32_16x16x16_bf16 v[24:27], v[98:99], v[176:177], v[24:27]
    v_mfma_f32_16x16x16_bf16 v[28:31], v[116:117], v[176:177], v[28:31]
    s_setprio 0
    s_nop 7
    v_cvt_pk_bf16_f32 v32, v20, v21
    v_cvt_pk_bf16_f32 v33, v22, v23
    buffer_store_dwordx2 v[32:33], v41, s[32:35], 0 offen offset:576
    v_cvt_pk_bf16_f32 v34, v24, v25
    v_cvt_pk_bf16_f32 v35, v26, v27
    buffer_store_dwordx2 v[34:35], v41, s[32:35], 0 offen offset:704
    s_cmp_lg_u32 s68, 0
    s_cbranch_scc1 L_pj_q1
    v_cvt_pk_bf16_f32 v36, v28, v29
    v_cvt_pk_bf16_f32 v37, v30, v31
    buffer_store_dwordx2 v[36:37], v41, s[32:35], 0 offen offset:832
L_pj_q1:
    s_waitcnt vmcnt(0)
    s_endpgm
L_end:
    s_endpgm
L_code_end:
.section .rodata,"a"
.p2align 6
.amdhsa_kernel standalone__autoregressive_conv_wavenet__speech_kernel
.amdhsa_next_free_vgpr 256
.amdhsa_next_free_sgpr 102
.amdhsa_accum_offset 256
.amdhsa_group_segment_fixed_size 0
.amdhsa_kernarg_size 48
.amdhsa_user_sgpr_count 2
.amdhsa_user_sgpr_kernarg_segment_ptr 1
.amdhsa_system_sgpr_workgroup_id_x 1
.amdhsa_float_denorm_mode_32 3
.end_amdhsa_kernel
```
